```python
import torch

def _softmax(x, axis=-1):
    return torch.softmax(x, dim=axis)
def _gelu(x):
    return torch.nn.functional.gelu(x, approximate="tanh")
def _silu(x):
    return torch.nn.functional.silu(x)
def _sigmoid(x):
    return torch.sigmoid(x)
def _layernorm(x, axis=-1, eps=1e-5):
    m = x.mean(dim=axis, keepdim=True)
    v = x.var(dim=axis, keepdim=True, unbiased=False)
    return (x - m) / torch.sqrt(v + eps)
def _scatter_add(tgt, idx, src, axis=0):
    return tgt.clone().index_add_(axis, idx, src)
def _segment_sum(src, seg, n):
    out = torch.zeros((n,) + src.shape[1:], dtype=src.dtype)
    return out.index_add_(0, seg, src)
def _pad(x, pw):
    flat = tuple(v for pair in reversed(pw) for v in pair)
    return torch.nn.functional.pad(x, flat)

kernel_name = 'standalone__molecular_angular_gemnet__graph'

def setup_inputs():

    _w = (lambda a: (lambda t: t.to(torch.bfloat16) if t.is_floating_point() else t)(torch.as_tensor(a)))
    N, deg, De, L = 10000, 16, 16, 1
    E = N * deg
    T = E * deg
    NR = 8
    dist = torch.rand(E).to(float)
    angle = (torch.rand(T) * torch.pi).to(float)
    centers = torch.linspace(0.0, 1.0, NR).to(float)
    ang_freq = torch.arange(1, L + 1).to(float)
    return {
        "m": _w((lambda *s: torch.randn(*s, dtype=torch.bfloat16) * 0.05)(E, De)),
        "idx_in": _w((lambda lo, hi, *s: torch.randint(lo, hi, s))(0, E, T).to(torch.int64)),
        "idx_out": _w((lambda lo, hi, *s: torch.randint(lo, hi, s))(0, E, T).to(torch.int64)),
        "dist": _w(dist),
        "angle": _w(angle),
        "centers": _w(centers),
        "ang_freq": _w(ang_freq),
        "w_rbf": _w((lambda *s: torch.randn(*s, dtype=torch.bfloat16) * 0.2)(NR, De)),
        "w_sbf": _w((lambda *s: torch.randn(*s, dtype=torch.bfloat16) * 0.2)(NR * L, De)),
        "w_down": _w((lambda *s: torch.randn(*s, dtype=torch.bfloat16) * 0.2)(De, De)),
        "w_up": _w((lambda *s: torch.randn(*s, dtype=torch.bfloat16) * 0.2)(De, De)),
    }

def reference(m, idx_in, idx_out, dist, angle, centers, ang_freq, w_rbf, w_sbf, w_down, w_up):
    E, De = m.shape[0], m.shape[1]
    NR = centers.shape[0]
    L = ang_freq.shape[0]
    rbf = torch.exp(-10.0 * (dist[:, None] - centers[None, :]) ** 2)
    cbf = torch.cos(ang_freq[None, :] * angle[:, None])
    rbf_t = rbf[idx_out]
    sbf = torch.reshape(rbf_t[:, :, None] * cbf[:, None, :], (-1, NR * L))
    x = (m[idx_in] @ w_down) * (sbf @ w_sbf)
    agg = _segment_sum(x, idx_out, E)
    return m + (agg @ w_up) * (rbf @ w_rbf)
```

```asm
; @launch grid=(256,1,1) block=(1024,1,1) lds=158768
.amdgcn_target "amdgcn-amd-amdhsa--gfx950"
.text
.globl standalone__molecular_angular_gemnet__graph_kernel
.p2align 8
.type standalone__molecular_angular_gemnet__graph_kernel,@function
standalone__molecular_angular_gemnet__graph_kernel:
    s_cmp_ge_u32 s2, 256
    s_cbranch_scc1 K_END
    s_load_dwordx16 s[4:19], s[0:1], 0
    s_load_dwordx8 s[20:27], s[0:1], 64
    s_load_dwordx4 s[28:31], s[0:1], 96
    v_lshlrev_b32 v1, 3, v0
    v_lshlrev_b32 v2, 2, v0
    v_lshlrev_b32 v94, 4, v0
    v_lshrrev_b32 v70, 6, v0
    v_and_b32 v95, 63, v0
    s_mul_i32 s52, s2, 40000
    s_mul_i32 s60, s2, 20000
    v_cmp_gt_u32 vcc, 1000, v0
    v_readfirstlane_b32 s3, v70
    s_add_u32 s53, s52, 8000
    s_add_u32 s61, s60, 4000
    s_add_u32 s54, s52, 16000
    s_add_u32 s62, s60, 8000
    s_add_u32 s55, s52, 24000
    s_add_u32 s63, s60, 12000
    s_add_u32 s56, s52, 32000
    s_add_u32 s57, s60, 16000
    s_mov_b64 s[68:69], vcc
    v_mov_b32 v84, 0
    v_mov_b32 v85, 0
    v_mov_b32 v86, 0
    v_mov_b32 v87, 0
    v_add_u32 v71, 153856, v94
    v_cmp_gt_u32 vcc, 130, v0
    v_mov_b32 v3, 6
    v_mov_b32 v29, 153856
    v_mov_b32 v65, 154880
    s_mov_b64 exec, vcc
    ds_write_b128 v71, v[84:87]
    s_mov_b64 exec, -1
    s_waitcnt lgkmcnt(0)
    s_barrier
    s_mov_b32 s36, s8
    s_and_b32 s37, s9, 0xffff
    s_mov_b32 s38, 10240000
    s_mov_b32 s39, 0x20000
    s_mov_b32 s32, s6
    s_and_b32 s33, s7, 0xffff
    s_mov_b32 s34, 10240000
    s_mov_b32 s35, 0x20000
    s_mov_b32 s40, s12
    s_and_b32 s41, s13, 0xffff
    s_mov_b32 s42, 5120000
    s_mov_b32 s43, 0x20000
    s_load_dword s73, s[16:17], 0
    s_add_u32 s48, s30, 16220160
    s_addc_u32 s49, s31, 0
    s_and_b32 s49, s49, 0xffff
    s_mov_b32 s50, 524288
    s_mov_b32 s51, 0x20000
    s_mul_i32 s79, s2, 2048
    s_cmp_lg_u32 s3, 0
    s_cbranch_scc1 KA_CLEARED
    buffer_store_dwordx4 v[84:87], v94, s[48:51], s79 offen sc1
    buffer_store_dwordx4 v[84:87], v94, s[48:51], s79 offen offset:1024 sc1
KA_CLEARED:
    s_and_b32 s72, s2, 7
    s_lshl_b32 s72, s72, 5
    s_lshr_b32 s74, s2, 3
    s_or_b32 s72, s72, s74
    s_cmp_lg_u32 s3, 2
    s_cbranch_scc1 KA_NO_DIST
    s_mov_b32 s64, s10
    s_and_b32 s65, s11, 0xffff
    s_mov_b32 s66, 320000
    s_mov_b32 s67, 0x20000
    s_mul_i32 s74, s72, 1250
    s_and_b32 s74, s74, -4
    v_lshl_add_u32 v70, v95, 4, s74
    buffer_load_dwordx4 v[76:79], v70, s[64:67], 0 offen
    s_mov_b64 exec, 0xffff
    buffer_load_dwordx4 v[80:83], v70, s[64:67], 0 offen offset:1024
    s_mov_b64 exec, -1
KA_NO_DIST:
    s_cmp_lg_u32 s3, 1
    s_cbranch_scc1 KA_NO_WEIGHTS
    v_lshlrev_b32 v70, 4, v95
    v_and_b32 v71, 0x1ff, v70
    s_mov_b32 exec_hi, 0
    global_load_dwordx4 v[76:79], v71, s[22:23]
    s_mov_b32 exec_lo, 0
    s_mov_b32 exec_hi, -1
    global_load_dwordx4 v[76:79], v71, s[24:25]
    v_and_b32 v71, 0xff, v70
    s_mov_b32 exec_hi, 1
    global_load_dwordx4 v[80:83], v71, s[14:15]
    s_mov_b64 exec, -1
    v_and_b32 v71, 0xff, v70
    s_mov_b64 exec, 0xffff
    global_load_dwordx4 v[80:83], v71, s[20:21]
    s_mov_b32 exec_lo, 0xffff0000
    global_load_dwordx4 v[80:83], v71, s[18:19]
    s_mov_b64 exec, -1
KA_NO_WEIGHTS:
    s_mov_b64 exec, s[68:69]
    s_setprio 3
    buffer_load_dwordx2 v[4:5], v1, s[36:39], s52 offen nt
    buffer_load_dwordx2 v[14:15], v1, s[32:35], s52 offen nt
    buffer_load_dwordx2 v[6:7], v1, s[36:39], s53 offen nt
    buffer_load_dwordx2 v[16:17], v1, s[32:35], s53 offen nt
    buffer_load_dwordx2 v[8:9], v1, s[36:39], s54 offen nt
    buffer_load_dwordx2 v[18:19], v1, s[32:35], s54 offen nt
    buffer_load_dwordx2 v[10:11], v1, s[36:39], s55 offen nt
    buffer_load_dwordx2 v[20:21], v1, s[32:35], s55 offen nt
    buffer_load_dwordx2 v[12:13], v1, s[36:39], s56 offen nt
    buffer_load_dwordx2 v[22:23], v1, s[32:35], s56 offen nt
    s_setprio 0
    s_cmp_lt_u32 s3, 13
    s_cbranch_scc1 KA_ANG_LATER
    buffer_load_dword v24, v2, s[40:43], s60 offen nt
    buffer_load_dword v25, v2, s[40:43], s61 offen nt
    buffer_load_dword v26, v2, s[40:43], s62 offen nt
    buffer_load_dword v27, v2, s[40:43], s63 offen nt
    buffer_load_dword v28, v2, s[40:43], s57 offen nt
KA_ANG_LATER:
    s_mov_b64 exec, -1
    v_add_u32 v70, 88320, v94
    v_add_u32 v71, 0x10000, v94
    v_cmp_gt_u32 vcc, 400, v0
    ds_write_b128 v70, v[84:87]
    ds_write_b128 v70, v[84:87] offset:16384
    ds_write_b128 v70, v[84:87] offset:32768
    ds_write_b128 v70, v[84:87] offset:49152
    ds_write_b128 v94, v[84:87]
    ds_write_b128 v94, v[84:87] offset:16384
    ds_write_b128 v94, v[84:87] offset:32768
    ds_write_b128 v94, v[84:87] offset:49152
    ds_write_b128 v71, v[84:87]
    s_mov_b64 exec, vcc
    ds_write_b128 v71, v[84:87] offset:16384
    s_mov_b64 exec, -1
    s_mul_i32 s78, s2, 63360
    s_add_u32 s78, s78, 0
    s_mov_b32 s81, 6871948
    s_mov_b32 s82, 80127
    s_mov_b32 s83, -625
    s_mov_b32 s84, 0xffff0000
    s_mov_b32 s85, 2048
    s_add_u32 s44, s30, s78
    s_addc_u32 s45, s31, 0
    s_and_b32 s45, s45, 0xffff
    s_mov_b32 s46, 0
    s_mov_b32 s47, 0x20000
    s_add_u32 s64, s30, 0
    s_addc_u32 s65, s31, 0
    s_and_b32 s65, s65, 0xffff
    s_or_b32 s65, s65, 786432
    s_mov_b32 s66, 1351680
    s_mov_b32 s67, 0x20000
    s_mov_b64 exec, s[68:69]
    s_cmp_lt_u32 s3, 13
    s_cbranch_scc0 KA_W0
    s_waitcnt vmcnt(8)
KA_W0:
    s_waitcnt vmcnt(13)
    v_mul_hi_u32_u24 v72, s81, v4
    v_mul_hi_u32_u24 v73, s81, v5
    v_cmp_le_u32 vcc, s82, v14
    v_cmp_le_u32 s[70:71], s82, v15
    v_mad_i32_i24 v74, v72, s83, v4
    v_mad_i32_i24 v75, v73, s83, v5
    v_cndmask_b32 v30, v29, v65, vcc
    v_cndmask_b32 v31, v29, v65, s[70:71]
    v_lshl_add_u32 v30, v72, 2, v30
    v_lshl_add_u32 v31, v73, 2, v31
    ds_add_rtn_u32 v40, v30, v3
    ds_add_rtn_u32 v41, v31, v3
    v_bfe_u32 v72, v74, 2, 1
    v_bfe_u32 v73, v75, 2, 1
    v_lshl_add_u32 v14, v14, 10, v74
    v_lshl_add_u32 v15, v15, 10, v75
    v_or_b32 v72, s85, v72
    v_or_b32 v73, s85, v73
    v_lshl_add_u32 v50, v14, 1, v72
    v_lshl_add_u32 v51, v15, 1, v73
    s_cmp_lt_u32 s3, 13
    s_cbranch_scc0 KA_W1
    s_waitcnt vmcnt(6)
KA_W1:
    s_waitcnt vmcnt(11)
    v_mul_hi_u32_u24 v72, s81, v6
    v_mul_hi_u32_u24 v73, s81, v7
    v_cmp_le_u32 vcc, s82, v16
    v_cmp_le_u32 s[70:71], s82, v17
    v_mad_i32_i24 v74, v72, s83, v6
    v_mad_i32_i24 v75, v73, s83, v7
    v_cndmask_b32 v32, v29, v65, vcc
    v_cndmask_b32 v33, v29, v65, s[70:71]
    v_lshl_add_u32 v32, v72, 2, v32
    v_lshl_add_u32 v33, v73, 2, v33
    ds_add_rtn_u32 v42, v32, v3
    ds_add_rtn_u32 v43, v33, v3
    v_bfe_u32 v72, v74, 2, 1
    v_bfe_u32 v73, v75, 2, 1
    v_lshl_add_u32 v16, v16, 10, v74
    v_lshl_add_u32 v17, v17, 10, v75
    v_or_b32 v72, s85, v72
    v_or_b32 v73, s85, v73
    v_lshl_add_u32 v52, v16, 1, v72
    v_lshl_add_u32 v53, v17, 1, v73
    s_cmp_lt_u32 s3, 13
    s_cbranch_scc0 KA_W2
    s_waitcnt vmcnt(4)
KA_W2:
    s_waitcnt vmcnt(9)
    v_mul_hi_u32_u24 v72, s81, v8
    v_mul_hi_u32_u24 v73, s81, v9
    v_cmp_le_u32 vcc, s82, v18
    v_cmp_le_u32 s[70:71], s82, v19
    v_mad_i32_i24 v74, v72, s83, v8
    v_mad_i32_i24 v75, v73, s83, v9
    v_cndmask_b32 v34, v29, v65, vcc
    v_cndmask_b32 v35, v29, v65, s[70:71]
    v_lshl_add_u32 v34, v72, 2, v34
    v_lshl_add_u32 v35, v73, 2, v35
    ds_add_rtn_u32 v44, v34, v3
    ds_add_rtn_u32 v45, v35, v3
    v_bfe_u32 v72, v74, 2, 1
    v_bfe_u32 v73, v75, 2, 1
    v_lshl_add_u32 v18, v18, 10, v74
    v_lshl_add_u32 v19, v19, 10, v75
    v_or_b32 v72, s85, v72
    v_or_b32 v73, s85, v73
    v_lshl_add_u32 v54, v18, 1, v72
    v_lshl_add_u32 v55, v19, 1, v73
    s_cmp_lt_u32 s3, 13
    s_cbranch_scc0 KA_W3
    s_waitcnt vmcnt(2)
KA_W3:
    s_waitcnt vmcnt(7)
    v_mul_hi_u32_u24 v72, s81, v10
    v_mul_hi_u32_u24 v73, s81, v11
    v_cmp_le_u32 vcc, s82, v20
    v_cmp_le_u32 s[70:71], s82, v21
    v_mad_i32_i24 v74, v72, s83, v10
    v_mad_i32_i24 v75, v73, s83, v11
    v_cndmask_b32 v36, v29, v65, vcc
    v_cndmask_b32 v37, v29, v65, s[70:71]
    v_lshl_add_u32 v36, v72, 2, v36
    v_lshl_add_u32 v37, v73, 2, v37
    ds_add_rtn_u32 v46, v36, v3
    ds_add_rtn_u32 v47, v37, v3
    v_bfe_u32 v72, v74, 2, 1
    v_bfe_u32 v73, v75, 2, 1
    v_lshl_add_u32 v20, v20, 10, v74
    v_lshl_add_u32 v21, v21, 10, v75
    v_or_b32 v72, s85, v72
    v_or_b32 v73, s85, v73
    v_lshl_add_u32 v56, v20, 1, v72
    v_lshl_add_u32 v57, v21, 1, v73
    s_cmp_lt_u32 s3, 13
    s_cbranch_scc0 KA_W4
    s_waitcnt vmcnt(0)
KA_W4:
    s_waitcnt vmcnt(5)
    v_mul_hi_u32_u24 v72, s81, v12
    v_mul_hi_u32_u24 v73, s81, v13
    v_cmp_le_u32 vcc, s82, v22
    v_cmp_le_u32 s[70:71], s82, v23
    v_mad_i32_i24 v74, v72, s83, v12
    v_mad_i32_i24 v75, v73, s83, v13
    v_cndmask_b32 v38, v29, v65, vcc
    v_cndmask_b32 v39, v29, v65, s[70:71]
    v_lshl_add_u32 v38, v72, 2, v38
    v_lshl_add_u32 v39, v73, 2, v39
    ds_add_rtn_u32 v48, v38, v3
    ds_add_rtn_u32 v49, v39, v3
    v_bfe_u32 v72, v74, 2, 1
    v_bfe_u32 v73, v75, 2, 1
    v_lshl_add_u32 v22, v22, 10, v74
    v_lshl_add_u32 v23, v23, 10, v75
    v_or_b32 v72, s85, v72
    v_or_b32 v73, s85, v73
    v_lshl_add_u32 v58, v22, 1, v72
    v_lshl_add_u32 v59, v23, 1, v73
    s_cmp_lt_u32 s3, 13
    s_cbranch_scc0 KA_ANG_DONE
    buffer_load_dword v24, v2, s[40:43], s60 offen nt
    buffer_load_dword v25, v2, s[40:43], s61 offen nt
    buffer_load_dword v26, v2, s[40:43], s62 offen nt
    buffer_load_dword v27, v2, s[40:43], s63 offen nt
    buffer_load_dword v28, v2, s[40:43], s57 offen nt
KA_ANG_DONE:
    s_mov_b64 exec, -1
    s_waitcnt lgkmcnt(0)
    s_lshl_b32 s73, s73, 16
    s_barrier
    s_cmp_eq_u32 s3, 0
    s_cbranch_scc1 KA_SCAN
    s_cmp_gt_u32 s3, 2
    s_cbranch_scc1 KA_SCANNED
    s_mov_b32 s74, 157488
    s_cmp_eq_u32 s3, 1
    s_cselect_b32 s74, 155936, s74
    s_cselect_b32 s75, -1, 0xffff
    s_cselect_b32 s76, 1, 0
    v_lshl_add_u32 v70, v95, 4, s74
    ds_write_b128 v70, v[76:79]
    s_mov_b32 exec_lo, s75
    s_mov_b32 exec_hi, s76
    ds_write_b128 v70, v[80:83] offset:1024
    s_mov_b64 exec, -1
    s_waitcnt lgkmcnt(0)
    s_branch KA_SCANNED
KA_SCAN:
    v_mov_b32 v70, 0
    v_mov_b32 v71, 1
    s_mov_b64 exec, 1
    global_atomic_add v70, v71, s[28:29]
    s_mov_b64 exec, -1
    v_lshlrev_b32 v70, 5, v95
    v_add_u32 v69, 153856, v70
    ds_read_b128 v[72:75], v69
    ds_read_b128 v[76:79], v69 offset:16
    s_mov_b32 s75, 43691
    s_waitcnt lgkmcnt(0)
    v_and_b32 v80, 2, v72
    v_and_b32 v81, 2, v73
    v_and_b32 v82, 2, v74
    v_and_b32 v83, 2, v75
    v_and_b32 v84, 2, v76
    v_and_b32 v85, 2, v77
    v_and_b32 v86, 2, v78
    v_and_b32 v87, 2, v79
    v_mad_u32_u24 v72, v80, 3, v72
    v_mad_u32_u24 v73, v81, 3, v73
    v_mad_u32_u24 v74, v82, 3, v74
    v_mad_u32_u24 v75, v83, 3, v75
    v_mad_u32_u24 v76, v84, 3, v76
    v_mad_u32_u24 v77, v85, 3, v77
    v_mad_u32_u24 v78, v86, 3, v78
    v_mad_u32_u24 v79, v87, 3, v79
    v_add_u32 v73, v72, v73
    v_add_u32 v74, v73, v74
    v_add_u32 v75, v74, v75
    v_add_u32 v76, v75, v76
    v_add_u32 v77, v76, v77
    v_add_u32 v78, v77, v78
    v_add_u32 v79, v78, v79
    v_mov_b32 v71, v79
    s_nop 1
    v_add_u32_dpp v71, v71, v71 row_shr:1 row_mask:0xf bank_mask:0xf bound_ctrl:0
    s_nop 1
    v_add_u32_dpp v71, v71, v71 row_shr:2 row_mask:0xf bank_mask:0xf bound_ctrl:0
    s_nop 1
    v_add_u32_dpp v71, v71, v71 row_shr:4 row_mask:0xf bank_mask:0xf bound_ctrl:0
    s_nop 1
    v_add_u32_dpp v71, v71, v71 row_shr:8 row_mask:0xf bank_mask:0xf bound_ctrl:0
    s_nop 1
    v_add_u32_dpp v71, v71, v71 row_bcast:15 row_mask:0xa bank_mask:0xf
    s_nop 1
    v_add_u32_dpp v71, v71, v71 row_bcast:31 row_mask:0xc bank_mask:0xf
    v_sub_u32 v80, v71, v79
    v_readlane_b32 s74, v71, 63
    v_add_u32 v81, v80, v72
    v_add_u32 v82, v80, v73
    v_add_u32 v83, v80, v74
    v_add_u32 v84, v80, v75
    v_add_u32 v85, v80, v76
    v_add_u32 v86, v80, v77
    v_add_u32 v87, v80, v78
    v_add_u32 v72, 88320, v80
    v_add_u32 v73, 88320, v81
    v_add_u32 v74, 88320, v82
    v_add_u32 v75, 88320, v83
    v_add_u32 v76, 88320, v84
    v_add_u32 v77, 88320, v85
    v_add_u32 v78, 88320, v86
    v_add_u32 v79, 88320, v87
    v_mov_b32 v88, s74
    ds_write_b128 v69, v[72:75]
    ds_write_b128 v69, v[76:79] offset:16
    ds_write_b32 v29, v88 offset:2048
    s_waitcnt lgkmcnt(0)
KA_SCANNED:
    s_barrier
    ds_read_b32 v68, v29 offset:2048
    s_mov_b64 exec, s[68:69]
    ds_read_b32 v14, v30
    ds_read_b32 v15, v31
    ds_read_b32 v16, v32
    ds_read_b32 v17, v33
    ds_read_b32 v18, v34
    ds_read_b32 v19, v35
    ds_read_b32 v20, v36
    ds_read_b32 v21, v37
    ds_read_b32 v22, v38
    ds_read_b32 v23, v39
    s_mov_b64 exec, -1
    s_cmp_lg_u32 s3, 0
    s_cbranch_scc1 KA_HAVE_ENTRIES
    v_mov_b32 v88, v71
    v_mul_u32_u24 v80, s75, v80
    v_mul_u32_u24 v81, s75, v81
    v_mul_u32_u24 v82, s75, v82
    v_mul_u32_u24 v83, s75, v83
    v_mul_u32_u24 v84, s75, v84
    v_mul_u32_u24 v85, s75, v85
    v_mul_u32_u24 v86, s75, v86
    v_mul_u32_u24 v87, s75, v87
    v_mul_u32_u24 v88, s75, v88
    v_lshrrev_b32 v80, 19, v80
    v_lshrrev_b32 v81, 19, v81
    v_lshrrev_b32 v82, 19, v82
    v_lshrrev_b32 v83, 19, v83
    v_lshrrev_b32 v84, 19, v84
    v_lshrrev_b32 v85, 19, v85
    v_lshrrev_b32 v86, 19, v86
    v_lshrrev_b32 v87, 19, v87
    v_lshrrev_b32 v88, 19, v88
    v_sub_u32 v72, v81, v80
    v_sub_u32 v74, v82, v81
    v_sub_u32 v76, v83, v82
    v_sub_u32 v78, v84, v83
    v_sub_u32 v73, v85, v84
    v_sub_u32 v75, v86, v85
    v_sub_u32 v77, v87, v86
    v_sub_u32 v79, v88, v87
    v_lshl_or_b32 v72, v72, 16, v80
    v_lshl_or_b32 v74, v74, 16, v81
    v_lshl_or_b32 v76, v76, 16, v82
    v_lshl_or_b32 v78, v78, 16, v83
    v_lshl_or_b32 v73, v73, 16, v84
    v_lshl_or_b32 v75, v75, 16, v85
    v_lshl_or_b32 v77, v77, 16, v86
    v_lshl_or_b32 v79, v79, 16, v87
    v_permlane32_swap_b32 v72, v73
    v_permlane32_swap_b32 v74, v75
    v_permlane32_swap_b32 v76, v77
    v_permlane32_swap_b32 v78, v79
    v_or_b32 v72, 0x80000000, v72
    v_or_b32 v74, 0x80000000, v74
    v_or_b32 v76, 0x80000000, v76
    v_or_b32 v78, 0x80000000, v78
KA_HAVE_ENTRIES:
    s_mov_b64 exec, s[68:69]
    v_and_b32 v30, 2, v40
    v_sub_u32 v40, v40, v30
    v_and_b32 v31, 2, v41
    v_sub_u32 v41, v41, v31
    v_and_b32 v32, 2, v42
    v_sub_u32 v42, v42, v32
    v_and_b32 v33, 2, v43
    v_sub_u32 v43, v43, v33
    v_and_b32 v34, 2, v44
    v_sub_u32 v44, v44, v34
    v_and_b32 v35, 2, v45
    v_sub_u32 v45, v45, v35
    v_and_b32 v36, 2, v46
    v_sub_u32 v46, v46, v36
    v_and_b32 v37, 2, v47
    v_sub_u32 v47, v47, v37
    v_and_b32 v38, 2, v48
    v_sub_u32 v48, v48, v38
    v_and_b32 v39, 2, v49
    v_sub_u32 v49, v49, v39
    s_waitcnt lgkmcnt(0)
    v_add_u32 v14, v14, v40
    ds_write_b32 v14, v50
    v_sub_u32 v30, v14, v30
    v_add_u32 v15, v15, v41
    ds_write_b32 v15, v51
    v_sub_u32 v31, v15, v31
    v_add_u32 v16, v16, v42
    ds_write_b32 v16, v52
    v_sub_u32 v32, v16, v32
    v_add_u32 v17, v17, v43
    ds_write_b32 v17, v53
    v_sub_u32 v33, v17, v33
    v_add_u32 v18, v18, v44
    ds_write_b32 v18, v54
    v_sub_u32 v34, v18, v34
    v_add_u32 v19, v19, v45
    ds_write_b32 v19, v55
    v_sub_u32 v35, v19, v35
    v_add_u32 v20, v20, v46
    ds_write_b32 v20, v56
    v_sub_u32 v36, v20, v36
    v_add_u32 v21, v21, v47
    ds_write_b32 v21, v57
    v_sub_u32 v37, v21, v37
    v_add_u32 v22, v22, v48
    ds_write_b32 v22, v58
    v_sub_u32 v38, v22, v38
    v_add_u32 v23, v23, v49
    ds_write_b32 v23, v59
    v_sub_u32 v39, v23, v39
    s_cmp_eq_u32 s3, 0
    s_cbranch_scc1 KA_ANGLES0
    s_waitcnt vmcnt(0)
KA_ANGLES0:
    s_waitcnt vmcnt(1)
    v_lshlrev_b32 v4, 16, v24
    v_and_b32 v5, s84, v24
    v_lshlrev_b32 v6, 16, v25
    v_and_b32 v7, s84, v25
    v_lshlrev_b32 v8, 16, v26
    v_and_b32 v9, s84, v26
    v_lshlrev_b32 v10, 16, v27
    v_and_b32 v11, s84, v27
    v_lshlrev_b32 v12, 16, v28
    v_and_b32 v13, s84, v28
    s_cmp_eq_u32 s73, 0x3f800000
    s_cbranch_scc1 K_UNIT_FREQA
    v_mul_f32 v4, s73, v4
    v_mul_f32 v5, s73, v5
    v_mul_f32 v6, s73, v6
    v_mul_f32 v7, s73, v7
    v_mul_f32 v8, s73, v8
    v_mul_f32 v9, s73, v9
    v_mul_f32 v10, s73, v10
    v_mul_f32 v11, s73, v11
    v_mul_f32 v12, s73, v12
    v_mul_f32 v13, s73, v13
    v_cvt_pk_bf16_f32 v4, v4, v5
    v_cvt_pk_bf16_f32 v6, v6, v7
    v_cvt_pk_bf16_f32 v8, v8, v9
    v_cvt_pk_bf16_f32 v10, v10, v11
    v_cvt_pk_bf16_f32 v12, v12, v13
    v_and_b32 v5, s84, v4
    v_lshlrev_b32 v4, 16, v4
    v_and_b32 v7, s84, v6
    v_lshlrev_b32 v6, 16, v6
    v_and_b32 v9, s84, v8
    v_lshlrev_b32 v8, 16, v8
    v_and_b32 v11, s84, v10
    v_lshlrev_b32 v10, 16, v10
    v_and_b32 v13, s84, v12
    v_lshlrev_b32 v12, 16, v12
K_UNIT_FREQA:
    v_mul_f32 v4, 0.15915494, v4
    v_mul_f32 v5, 0.15915494, v5
    v_mul_f32 v6, 0.15915494, v6
    v_mul_f32 v7, 0.15915494, v7
    v_mul_f32 v8, 0.15915494, v8
    v_mul_f32 v9, 0.15915494, v9
    v_mul_f32 v10, 0.15915494, v10
    v_mul_f32 v11, 0.15915494, v11
    v_mul_f32 v12, 0.15915494, v12
    v_mul_f32 v13, 0.15915494, v13
    v_fract_f32 v4, v4
    v_fract_f32 v5, v5
    v_fract_f32 v6, v6
    v_fract_f32 v7, v7
    v_fract_f32 v8, v8
    v_fract_f32 v9, v9
    v_fract_f32 v10, v10
    v_fract_f32 v11, v11
    v_fract_f32 v12, v12
    v_fract_f32 v13, v13
    v_cos_f32 v4, v4
    v_cos_f32 v5, v5
    v_cos_f32 v6, v6
    v_cos_f32 v7, v7
    v_cos_f32 v8, v8
    v_cos_f32 v9, v9
    v_cos_f32 v10, v10
    v_cos_f32 v11, v11
    v_cos_f32 v12, v12
    v_cos_f32 v13, v13
    v_cvt_pk_bf16_f32 v60, v4, v5
    v_cvt_pk_bf16_f32 v61, v6, v7
    v_cvt_pk_bf16_f32 v62, v8, v9
    v_cvt_pk_bf16_f32 v63, v10, v11
    v_cvt_pk_bf16_f32 v64, v12, v13
    ds_write_b16 v30, v60 offset:8
    ds_write_b16_d16_hi v31, v60 offset:8
    ds_write_b16 v32, v61 offset:8
    ds_write_b16_d16_hi v33, v61 offset:8
    ds_write_b16 v34, v62 offset:8
    ds_write_b16_d16_hi v35, v62 offset:8
    ds_write_b16 v36, v63 offset:8
    ds_write_b16_d16_hi v37, v63 offset:8
    ds_write_b16 v38, v64 offset:8
    ds_write_b16_d16_hi v39, v64 offset:8
    s_mov_b64 exec, -1
    v_readfirstlane_b32 s46, v68
    v_add_u32 v69, 88320, v94
    v_add_u32 v66, 16384, v94
    v_add_u32 v67, 32768, v94
    v_add_u32 v68, 49152, v94
    s_add_u32 s46, s46, 15
    s_and_b32 s46, s46, -16
    s_waitcnt lgkmcnt(0)
    s_barrier
    ds_read_b128 v[4:7], v69 offset:0
    ds_read_b128 v[8:11], v69 offset:16384
    ds_read_b128 v[12:15], v69 offset:32768
    ds_read_b128 v[16:19], v69 offset:49152
    s_waitcnt lgkmcnt(3)
    buffer_store_dwordx4 v[4:7], v94, s[44:47], 0 offen sc1
    s_waitcnt lgkmcnt(2)
    buffer_store_dwordx4 v[8:11], v66, s[44:47], 0 offen sc1
    s_waitcnt lgkmcnt(1)
    buffer_store_dwordx4 v[12:15], v67, s[44:47], 0 offen sc1
    s_waitcnt lgkmcnt(0)
    buffer_store_dwordx4 v[16:19], v68, s[44:47], 0 offen sc1
    s_mul_i32 s74, s72, 625
    s_lshl_b32 s75, s3, 4
    v_and_b32 v20, 15, v95
    v_lshrrev_b32 v21, 4, v95
    v_add_u32 v22, s75, v20
    v_lshlrev_b32 v23, 3, v21
    s_lshl_b32 s76, s72, 1
    s_and_b32 s76, s76, 2
    s_add_u32 s76, s76, 157488
    v_mov_b32 v26, 0x80000000
    v_lshl_add_u32 v27, v22, 1, s76
    v_mov_b32 v96, 0xffff0000
    ds_read_u16 v108, v27 offset:0
    ds_read_u16 v109, v27 offset:512
    ds_read_u16 v110, v27 offset:1024
    s_mov_b32 s52, s4
    s_and_b32 s53, s5, 0xffff
    s_mov_b32 s54, 5120000
    s_mov_b32 s55, 0x20000
    s_mov_b32 s60, s26
    s_and_b32 s61, s27, 0xffff
    s_mov_b32 s62, 5120000
    s_mov_b32 s63, 0x20000
    v_add_u32 v24, 0, v22
    v_cmp_gt_u32 vcc, 625, v24
    v_add_u32 v24, s74, v24
    v_lshl_add_u32 v25, v24, 5, v23
    v_cndmask_b32 v97, v26, v25, vcc
    v_add_u32 v24, 256, v22
    v_cmp_gt_u32 vcc, 625, v24
    v_add_u32 v24, s74, v24
    v_lshl_add_u32 v25, v24, 5, v23
    v_cndmask_b32 v126, v26, v25, vcc
    v_add_u32 v24, 512, v22
    v_cmp_gt_u32 vcc, 625, v24
    v_add_u32 v24, s74, v24
    v_lshl_add_u32 v25, v24, 5, v23
    v_cndmask_b32 v127, v26, v25, vcc
    v_lshlrev_b32 v40, 3, v95
    v_lshrrev_b32 v41, 4, v95
    v_and_b32 v42, 63, v40
    v_add_u32 v40, 155936, v40
    v_lshl_add_u32 v42, v41, 6, v42
    v_lshlrev_b32 v41, 2, v41
    v_add_u32 v42, 156960, v42
    v_add_u32 v41, 157472, v41
    ds_read_b64_tr_b16 v[104:105], v40
    ds_read_b64_tr_b16 v[106:107], v40 offset:512
    ds_read_b64_tr_b16 v[34:35], v42
    ds_read_b64_tr_b16 v[36:37], v42 offset:256
    ds_read_b32 v33, v41
    s_mov_b32 s74, 0xc1200000
    s_mov_b32 s75, 0x3fb8aa3b
    s_waitcnt lgkmcnt(0)
    v_lshlrev_b32 v32, 16, v33
    v_and_b32 v33, v96, v33
    v_mov_b32 v41, 0
    v_mov_b32 v45, 0
    v_mov_b32 v49, 0
    v_lshlrev_b32 v108, 16, v108
    v_lshlrev_b32 v109, 16, v109
    v_lshlrev_b32 v110, 16, v110
    v_sub_f32 v42, v108, v32
    v_sub_f32 v43, v108, v33
    v_sub_f32 v46, v109, v32
    v_sub_f32 v47, v109, v33
    v_sub_f32 v50, v110, v32
    v_sub_f32 v51, v110, v33
    v_cvt_pk_bf16_f32 v42, v42, v43
    v_cvt_pk_bf16_f32 v46, v46, v47
    v_cvt_pk_bf16_f32 v50, v50, v51
    v_and_b32 v43, v96, v42
    v_and_b32 v47, v96, v46
    v_and_b32 v51, v96, v50
    v_lshlrev_b32 v42, 16, v42
    v_lshlrev_b32 v46, 16, v46
    v_lshlrev_b32 v50, 16, v50
    v_mul_f32 v42, v42, v42
    v_mul_f32 v43, v43, v43
    v_mul_f32 v46, v46, v46
    v_mul_f32 v47, v47, v47
    v_mul_f32 v50, v50, v50
    v_mul_f32 v51, v51, v51
    v_cvt_pk_bf16_f32 v42, v42, v43
    v_cvt_pk_bf16_f32 v46, v46, v47
    v_cvt_pk_bf16_f32 v50, v50, v51
    v_and_b32 v43, v96, v42
    v_and_b32 v47, v96, v46
    v_and_b32 v51, v96, v50
    v_lshlrev_b32 v42, 16, v42
    v_lshlrev_b32 v46, 16, v46
    v_lshlrev_b32 v50, 16, v50
    v_mul_f32 v42, s74, v42
    v_mul_f32 v43, s74, v43
    v_mul_f32 v46, s74, v46
    v_mul_f32 v47, s74, v47
    v_mul_f32 v50, s74, v50
    v_mul_f32 v51, s74, v51
    v_cvt_pk_bf16_f32 v42, v42, v43
    v_cvt_pk_bf16_f32 v46, v46, v47
    v_cvt_pk_bf16_f32 v50, v50, v51
    v_and_b32 v43, v96, v42
    v_and_b32 v47, v96, v46
    v_and_b32 v51, v96, v50
    v_lshlrev_b32 v42, 16, v42
    v_lshlrev_b32 v46, 16, v46
    v_lshlrev_b32 v50, 16, v50
    v_mul_f32 v42, s75, v42
    v_mul_f32 v43, s75, v43
    v_mul_f32 v46, s75, v46
    v_mul_f32 v47, s75, v47
    v_mul_f32 v50, s75, v50
    v_mul_f32 v51, s75, v51
    v_exp_f32 v42, v42
    v_exp_f32 v43, v43
    v_exp_f32 v46, v46
    v_exp_f32 v47, v47
    v_exp_f32 v50, v50
    v_exp_f32 v51, v51
    v_cvt_pk_bf16_f32 v40, v42, v43
    v_cvt_pk_bf16_f32 v44, v46, v47
    v_cvt_pk_bf16_f32 v48, v50, v51
    v_mfma_f32_16x16x16_bf16 v[108:111], v[34:35], v[40:41], 0
    v_mfma_f32_16x16x16_bf16 v[112:115], v[34:35], v[44:45], 0
    v_mfma_f32_16x16x16_bf16 v[116:119], v[34:35], v[48:49], 0
    v_mfma_f32_16x16x16_bf16 v[52:55], v[36:37], v[48:49], 0
    s_nop 3
    v_mfma_f32_16x16x16_bf16 v[48:51], v[36:37], v[44:45], 0
    s_nop 3
    v_mfma_f32_16x16x16_bf16 v[44:47], v[36:37], v[40:41], 0
    v_cvt_pk_bf16_f32 v124, v52, v53
    v_cvt_pk_bf16_f32 v125, v54, v55
    s_nop 0
    v_cvt_pk_bf16_f32 v122, v48, v49
    v_cvt_pk_bf16_f32 v123, v50, v51
    s_nop 2
    v_cvt_pk_bf16_f32 v120, v44, v45
    v_cvt_pk_bf16_f32 v121, v46, v47
    v_mov_b32 v1, v95
    v_and_b32 v32, 1, v1
    v_bfe_u32 v33, v1, 1, 3
    v_lshlrev_b32 v2, 4, v32
    v_lshlrev_b32 v3, 6, v32
    v_subrev_u32 v2, 32, v2
    v_lshl_add_u32 v3, v33, 3, v3
    v_mov_b32 v94, 8
    s_mov_b32 s74, 0x02020000
    s_mov_b32 s75, 0x01000c0c
    s_mov_b32 s70, 0xff00ff00
    s_mov_b32 s71, 0xff00ff00
    v_lshrrev_b32 v34, 1, v1
    v_lshlrev_b32 v34, 3, v34
    v_lshl_add_u32 v92, v32, 13, v34
    s_lshl_b32 s76, s3, 8
    s_add_u32 s76, s76, 88320
    v_lshlrev_b32 v93, 1, v32
    v_and_b32 v33, 3, v33
    v_add_u32 v92, s76, v92
    v_and_b32 v38, 15, v1
    v_lshrrev_b32 v35, 4, v1
    v_add_u32 v39, 1, v38
    v_lshl_add_u32 v46, v38, 2, v35
    v_lshlrev_b32 v46, 14, v46
    v_and_b32 v47, 31, v1
    v_lshrrev_b32 v34, 5, v1
    v_lshlrev_b32 v47, 6, v47
    v_lshl_add_u32 v47, v34, 5, v47
    s_lshr_b32 s76, s3, 3
    s_lshl_b32 s76, s76, 18
    s_and_b32 s77, s3, 7
    s_lshl_b32 s77, s77, 11
    s_add_u32 s76, s76, s77
    v_add_u32 v31, s76, v46
    v_lshrrev_b32 v31, 11, v31
    v_mul_u32_u24 v31, 5280, v31
    s_lshl_b32 s77, s72, 3
    s_add_u32 s76, s76, s77
    v_mov_b32 v44, 0
    v_mov_b32 v45, 0
    v_mov_b32 v36, 0
    v_xor_b32 v34, 0, v33
    v_mul_lo_u32 v34, v34, s74
    v_add_u32 v4, s75, v34
    v_xor_b32 v34, 1, v33
    v_mul_lo_u32 v34, v34, s74
    v_add_u32 v5, s75, v34
    v_xor_b32 v34, 2, v33
    v_mul_lo_u32 v34, v34, s74
    v_add_u32 v6, s75, v34
    v_xor_b32 v34, 3, v33
    v_mul_lo_u32 v34, v34, s74
    v_add_u32 v7, s75, v34
    s_mov_b32 s77, 0x40000
    s_cmp_lg_u32 s3, 0
    s_cbranch_scc1 KB_ROWS_CLEAR
KB_POLL_CLEAR:
    global_load_dword v37, v36, s[28:29] sc1
    s_waitcnt vmcnt(0)
    v_readfirstlane_b32 s74, v37
    s_nop 0
    s_cmp_ge_u32 s74, 256
    s_cbranch_scc1 KB_ROWS_CLEAR
    s_sub_u32 s77, s77, 1
    s_cbranch_scc1 K_END
    s_sleep 16
    s_branch KB_POLL_CLEAR
KB_ROWS_CLEAR:
    s_waitcnt vmcnt(0)
    s_barrier
    s_cmp_lg_u32 s3, 0
    s_cbranch_scc1 KB_PUBLISHED
    buffer_store_dwordx4 v[72:75], v47, s[48:51], s79 offen sc1
    buffer_store_dwordx4 v[76:79], v47, s[48:51], s79 offen offset:16 sc1
KB_PUBLISHED:
    s_mov_b32 exec_lo, 0x000f000f
    s_mov_b32 exec_hi, 0x000f000f
    s_mov_b32 s85, 0
KB_POLL:
    buffer_load_dwordx2 v[44:45], v46, s[48:51], s76 offen sc1
    s_waitcnt vmcnt(0)
    v_cmpx_le_i32 vcc, 0, v44
    s_sub_u32 s77, s77, 1
    s_cbranch_execz KB_READY
    s_cbranch_scc1 K_END
    s_sleep 2
    s_branch KB_POLL
KB_READY:
    s_mov_b64 exec, -1
    s_nop 1
    v_and_b32 v40, 0xffff, v44
    v_bfe_u32 v42, v44, 16, 15
    v_and_b32 v41, 0xffff, v45
    v_lshrrev_b32 v43, 16, v45
    s_mov_b32 s77, 0x80000000
    s_mov_b32 s86, 0
    v_add_u32 v40, v40, v31
    v_add_u32 v41, v41, v31
    v_cmp_lt_u32 vcc, 16, v42
    s_mov_b32 s81, 0
    s_cbranch_vccz KB_SHORT0
    s_mov_b32 s81, 1
    s_bcnt1_i32_b64 s74, vcc
    v_cmp_lt_u32 s[68:69], 32, v42
    s_cmp_gt_u32 s74, 4
    s_cselect_b32 s86, 1, s86
    v_mov_b32 v26, 0
    v_mov_b32 v27, 0
    s_cmp_lg_u64 s[68:69], 0
    s_cselect_b32 s86, 1, s86
    s_ff1_i32_b64 s74, vcc
    s_bitset0_b64 vcc, s74
    v_readlane_b32 s75, v40, s74
    v_readlane_b32 s74, v42, s74
    s_add_u32 s75, s75, 16
    s_sub_u32 s74, s74, 16
    v_writelane_b32 v26, s75, 0
    v_writelane_b32 v27, s74, 0
    s_cmp_eq_u64 vcc, 0
    s_cbranch_scc1 KB_LONG0
    s_ff1_i32_b64 s74, vcc
    s_bitset0_b64 vcc, s74
    v_readlane_b32 s75, v40, s74
    v_readlane_b32 s74, v42, s74
    s_add_u32 s75, s75, 16
    s_sub_u32 s74, s74, 16
    v_writelane_b32 v26, s75, 16
    v_writelane_b32 v27, s74, 16
    s_cmp_eq_u64 vcc, 0
    s_cbranch_scc1 KB_LONG0
    s_ff1_i32_b64 s74, vcc
    s_bitset0_b64 vcc, s74
    v_readlane_b32 s75, v40, s74
    v_readlane_b32 s74, v42, s74
    s_add_u32 s75, s75, 16
    s_sub_u32 s74, s74, 16
    v_writelane_b32 v26, s75, 32
    v_writelane_b32 v27, s74, 32
    s_cmp_eq_u64 vcc, 0
    s_cbranch_scc1 KB_LONG0
    s_ff1_i32_b64 s74, vcc
    s_bitset0_b64 vcc, s74
    v_readlane_b32 s75, v40, s74
    v_readlane_b32 s74, v42, s74
    s_add_u32 s75, s75, 16
    s_sub_u32 s74, s74, 16
    v_writelane_b32 v26, s75, 48
    v_writelane_b32 v27, s74, 48
KB_LONG0:
    s_nop 1
    v_add_u32_dpp v24, v26, v38 row_newbcast:0 row_mask:0xf bank_mask:0xf
    v_sub_u32_dpp v25, v27, v39 row_newbcast:0 row_mask:0xf bank_mask:0xf
    v_and_or_b32 v24, v25, s77, v24
    buffer_load_dwordx3 v[24:26], v24, s[64:67], 0 idxen sc1
KB_SHORT0:
    v_add_u32_dpp v8, v40, v38 row_newbcast:0 row_mask:0xf bank_mask:0xf
    v_sub_u32_dpp v9, v42, v39 row_newbcast:0 row_mask:0xf bank_mask:0xf
    v_and_or_b32 v8, v9, s77, v8
    buffer_load_dwordx3 v[8:10], v8, s[64:67], 0 idxen sc1
    v_add_u32_dpp v12, v40, v38 row_newbcast:1 row_mask:0xf bank_mask:0xf
    v_sub_u32_dpp v13, v42, v39 row_newbcast:1 row_mask:0xf bank_mask:0xf
    v_and_or_b32 v12, v13, s77, v12
    buffer_load_dwordx3 v[12:14], v12, s[64:67], 0 idxen sc1
    v_add_u32_dpp v16, v40, v38 row_newbcast:2 row_mask:0xf bank_mask:0xf
    v_sub_u32_dpp v17, v42, v39 row_newbcast:2 row_mask:0xf bank_mask:0xf
    v_and_or_b32 v16, v17, s77, v16
    buffer_load_dwordx3 v[16:18], v16, s[64:67], 0 idxen sc1
    v_add_u32_dpp v20, v40, v38 row_newbcast:3 row_mask:0xf bank_mask:0xf
    v_sub_u32_dpp v21, v42, v39 row_newbcast:3 row_mask:0xf bank_mask:0xf
    v_and_or_b32 v20, v21, s77, v20
    buffer_load_dwordx3 v[20:22], v20, s[64:67], 0 idxen sc1
    v_cmp_lt_u32 vcc, 16, v43
    s_mov_b32 s82, 0
    s_cbranch_vccz KB_SHORT1
    s_mov_b32 s82, 1
    s_bcnt1_i32_b64 s74, vcc
    v_cmp_lt_u32 s[68:69], 32, v43
    s_cmp_gt_u32 s74, 4
    s_cselect_b32 s86, 1, s86
    v_mov_b32 v90, 0
    v_mov_b32 v91, 0
    s_cmp_lg_u64 s[68:69], 0
    s_cselect_b32 s86, 1, s86
    s_ff1_i32_b64 s74, vcc
    s_bitset0_b64 vcc, s74
    v_readlane_b32 s75, v41, s74
    v_readlane_b32 s74, v43, s74
    s_add_u32 s75, s75, 16
    s_sub_u32 s74, s74, 16
    v_writelane_b32 v90, s75, 0
    v_writelane_b32 v91, s74, 0
    s_cmp_eq_u64 vcc, 0
    s_cbranch_scc1 KB_LONG1
    s_ff1_i32_b64 s74, vcc
    s_bitset0_b64 vcc, s74
    v_readlane_b32 s75, v41, s74
    v_readlane_b32 s74, v43, s74
    s_add_u32 s75, s75, 16
    s_sub_u32 s74, s74, 16
    v_writelane_b32 v90, s75, 16
    v_writelane_b32 v91, s74, 16
    s_cmp_eq_u64 vcc, 0
    s_cbranch_scc1 KB_LONG1
    s_ff1_i32_b64 s74, vcc
    s_bitset0_b64 vcc, s74
    v_readlane_b32 s75, v41, s74
    v_readlane_b32 s74, v43, s74
    s_add_u32 s75, s75, 16
    s_sub_u32 s74, s74, 16
    v_writelane_b32 v90, s75, 32
    v_writelane_b32 v91, s74, 32
    s_cmp_eq_u64 vcc, 0
    s_cbranch_scc1 KB_LONG1
    s_ff1_i32_b64 s74, vcc
    s_bitset0_b64 vcc, s74
    v_readlane_b32 s75, v41, s74
    v_readlane_b32 s74, v43, s74
    s_add_u32 s75, s75, 16
    s_sub_u32 s74, s74, 16
    v_writelane_b32 v90, s75, 48
    v_writelane_b32 v91, s74, 48
KB_LONG1:
    s_nop 1
    v_add_u32_dpp v88, v90, v38 row_newbcast:0 row_mask:0xf bank_mask:0xf
    v_sub_u32_dpp v89, v91, v39 row_newbcast:0 row_mask:0xf bank_mask:0xf
    v_and_or_b32 v88, v89, s77, v88
KB_SHORT1:
    v_add_u32_dpp v48, v41, v38 row_newbcast:0 row_mask:0xf bank_mask:0xf
    v_sub_u32_dpp v49, v43, v39 row_newbcast:0 row_mask:0xf bank_mask:0xf
    v_and_or_b32 v48, v49, s77, v48
    v_add_u32_dpp v52, v41, v38 row_newbcast:1 row_mask:0xf bank_mask:0xf
    v_sub_u32_dpp v53, v43, v39 row_newbcast:1 row_mask:0xf bank_mask:0xf
    v_and_or_b32 v52, v53, s77, v52
    v_add_u32_dpp v56, v41, v38 row_newbcast:2 row_mask:0xf bank_mask:0xf
    v_sub_u32_dpp v57, v43, v39 row_newbcast:2 row_mask:0xf bank_mask:0xf
    v_and_or_b32 v56, v57, s77, v56
    v_add_u32_dpp v60, v41, v38 row_newbcast:3 row_mask:0xf bank_mask:0xf
    v_sub_u32_dpp v61, v43, v39 row_newbcast:3 row_mask:0xf bank_mask:0xf
    v_and_or_b32 v60, v61, s77, v60
    v_add_u32_dpp v36, v43, v43 quad_perm:[1,0,3,2] row_mask:0xf bank_mask:0xf
    s_lshl_b32 s74, s86, 20
    v_mov_b32 v35, 0
    v_add_u32_dpp v36, v36, v36 quad_perm:[2,3,0,1] row_mask:0xf bank_mask:0xf
    v_add_u32 v36, s74, v36
    s_mov_b32 exec_lo, 0x00010001
    s_mov_b32 exec_hi, 0x00010001
    ds_add_u32 v35, v36 offset:6144
    s_mov_b64 exec, -1
    s_waitcnt vmcnt(3)
    v_lshrrev_b32 v64, 16, v8
    v_lshrrev_b32 v65, 16, v9
    v_and_b32 v64, -4, v64
    v_and_b32 v65, -4, v65
    v_cmpx_ne_u32 vcc, 0, v8
    ds_add_rtn_u32 v74, v64, v94
    s_mov_b64 exec, -1
    v_cmpx_ne_u32 vcc, 0, v9
    ds_add_rtn_u32 v75, v65, v94
    s_mov_b64 exec, -1
    s_waitcnt vmcnt(2)
    v_lshrrev_b32 v66, 16, v12
    v_lshrrev_b32 v67, 16, v13
    v_and_b32 v66, -4, v66
    v_and_b32 v67, -4, v67
    v_cmpx_ne_u32 vcc, 0, v12
    ds_add_rtn_u32 v76, v66, v94
    s_mov_b64 exec, -1
    v_cmpx_ne_u32 vcc, 0, v13
    ds_add_rtn_u32 v77, v67, v94
    s_mov_b64 exec, -1
    s_waitcnt vmcnt(1)
    v_lshrrev_b32 v68, 16, v16
    v_lshrrev_b32 v69, 16, v17
    v_and_b32 v68, -4, v68
    v_and_b32 v69, -4, v69
    v_cmpx_ne_u32 vcc, 0, v16
    ds_add_rtn_u32 v78, v68, v94
    s_mov_b64 exec, -1
    v_cmpx_ne_u32 vcc, 0, v17
    ds_add_rtn_u32 v79, v69, v94
    s_mov_b64 exec, -1
    s_waitcnt vmcnt(0)
    v_lshrrev_b32 v70, 16, v20
    v_lshrrev_b32 v71, 16, v21
    v_and_b32 v70, -4, v70
    v_and_b32 v71, -4, v71
    v_cmpx_ne_u32 vcc, 0, v20
    ds_add_rtn_u32 v80, v70, v94
    s_mov_b64 exec, -1
    v_cmpx_ne_u32 vcc, 0, v21
    ds_add_rtn_u32 v81, v71, v94
    s_mov_b64 exec, -1
    s_cmp_eq_u32 s81, 0
    s_cbranch_scc1 KB_HISTED0
    v_lshrrev_b32 v72, 16, v24
    v_lshrrev_b32 v73, 16, v25
    v_and_b32 v72, -4, v72
    v_and_b32 v73, -4, v73
    v_cmpx_ne_u32 vcc, 0, v24
    ds_add_rtn_u32 v82, v72, v94
    s_mov_b64 exec, -1
    v_cmpx_ne_u32 vcc, 0, v25
    ds_add_rtn_u32 v83, v73, v94
    s_mov_b64 exec, -1
KB_HISTED0:
    s_cmp_lg_u32 s3, 0
    s_cbranch_scc1 KB_CONV0W
    v_and_b32 v11, 0x7ff, v9
    v_lshrrev_b32 v84, 6, v9
    v_and_b32 v9, 0x7ff, v8
    v_lshrrev_b32 v8, 6, v8
    v_and_or_b32 v11, v10, v96, v11
    v_lshl_or_b32 v9, v10, 16, v9
    v_and_b32 v10, -32, v84
    v_and_b32 v8, -32, v8
    v_and_b32 v15, 0x7ff, v13
    v_lshrrev_b32 v84, 6, v13
    v_and_b32 v13, 0x7ff, v12
    v_lshrrev_b32 v12, 6, v12
    v_and_or_b32 v15, v14, v96, v15
    v_lshl_or_b32 v13, v14, 16, v13
    v_and_b32 v14, -32, v84
    v_and_b32 v12, -32, v12
    v_and_b32 v19, 0x7ff, v17
    v_lshrrev_b32 v84, 6, v17
    v_and_b32 v17, 0x7ff, v16
    v_lshrrev_b32 v16, 6, v16
    v_and_or_b32 v19, v18, v96, v19
    v_lshl_or_b32 v17, v18, 16, v17
    v_and_b32 v18, -32, v84
    v_and_b32 v16, -32, v16
    v_and_b32 v23, 0x7ff, v21
    v_lshrrev_b32 v84, 6, v21
    v_and_b32 v21, 0x7ff, v20
    v_lshrrev_b32 v20, 6, v20
    v_and_or_b32 v23, v22, v96, v23
    v_lshl_or_b32 v21, v22, 16, v21
    v_and_b32 v22, -32, v84
    v_and_b32 v20, -32, v20
    s_cmp_eq_u32 s81, 0
    s_cbranch_scc1 KB_CONV0W
    v_and_b32 v27, 0x7ff, v25
    v_lshrrev_b32 v84, 6, v25
    v_and_b32 v25, 0x7ff, v24
    v_lshrrev_b32 v24, 6, v24
    v_and_or_b32 v27, v26, v96, v27
    v_lshl_or_b32 v25, v26, 16, v25
    v_and_b32 v26, -32, v84
    v_and_b32 v24, -32, v24
KB_CONV0W:
    s_waitcnt lgkmcnt(0)
    s_barrier
    s_cmp_lg_u32 s3, 0
    s_cbranch_scc1 KB_NOSCAN0
    v_mul_u32_u24 v84, 48, v1
    ds_read_b128 v[28:31], v84 offset:0
    ds_read_b128 v[32:35], v84 offset:16
    ds_read_b128 v[36:39], v84 offset:32
    v_mov_b32 v86, 0
    s_waitcnt lgkmcnt(0)
    v_add_u32 v29, v28, v29
    v_add_u32 v30, v29, v30
    v_add_u32 v31, v30, v31
    v_add_u32 v32, v31, v32
    v_add_u32 v33, v32, v33
    v_add_u32 v34, v33, v34
    v_add_u32 v35, v34, v35
    v_add_u32 v36, v35, v36
    v_add_u32 v37, v36, v37
    v_add_u32 v38, v37, v38
    v_add_u32 v39, v38, v39
    v_mov_b32 v85, v39
    s_nop 1
    v_add_u32_dpp v85, v85, v85 row_shr:1 row_mask:0xf bank_mask:0xf bound_ctrl:0
    s_nop 1
    v_add_u32_dpp v85, v85, v85 row_shr:2 row_mask:0xf bank_mask:0xf bound_ctrl:0
    s_nop 1
    v_add_u32_dpp v85, v85, v85 row_shr:4 row_mask:0xf bank_mask:0xf bound_ctrl:0
    s_nop 1
    v_add_u32_dpp v85, v85, v85 row_shr:8 row_mask:0xf bank_mask:0xf bound_ctrl:0
    s_nop 1
    v_add_u32_dpp v85, v85, v85 row_bcast:15 row_mask:0xa bank_mask:0xf
    s_nop 1
    v_add_u32_dpp v85, v85, v85 row_bcast:31 row_mask:0xc bank_mask:0xf
    s_nop 0
    v_readlane_b32 s74, v85, 63
    v_sub_u32 v85, v85, v39
    v_add_u32 v85, 88320, v85
    v_add_u32 v39, v85, v38
    v_add_u32 v38, v85, v37
    v_add_u32 v37, v85, v36
    v_add_u32 v36, v85, v35
    v_add_u32 v35, v85, v34
    v_add_u32 v34, v85, v33
    v_add_u32 v33, v85, v32
    v_add_u32 v32, v85, v31
    v_add_u32 v31, v85, v30
    v_add_u32 v30, v85, v29
    v_add_u32 v29, v85, v28
    v_mov_b32 v28, v85
    s_or_b32 s75, s74, 0x80000000
    s_min_u32 s74, s74, 49152
    s_add_u32 s74, s74, 88320
    v_mov_b32 v87, s75
    v_lshl_add_u32 v85, v1, 2, s74
    ds_write_b128 v84, v[28:31] offset:0
    ds_write_b128 v84, v[32:35] offset:16
    ds_write_b128 v84, v[36:39] offset:32
    ds_write_b32 v85, v86
    ds_write_b32 v86, v87 offset:6160
KB_NOSCAN0:
    buffer_load_dwordx3 v[48:50], v48, s[64:67], 0 idxen sc1
    buffer_load_dwordx3 v[52:54], v52, s[64:67], 0 idxen sc1
    buffer_load_dwordx3 v[56:58], v56, s[64:67], 0 idxen sc1
    buffer_load_dwordx3 v[60:62], v60, s[64:67], 0 idxen sc1
    s_cmp_eq_u32 s82, 0
    s_cbranch_scc1 KB_RAW1
    buffer_load_dwordx3 v[88:90], v88, s[64:67], 0 idxen sc1
KB_RAW1:
    s_cmp_eq_u32 s3, 0
    s_cbranch_scc1 KB_CONV0
    v_and_b32 v11, 0x7ff, v9
    v_lshrrev_b32 v84, 6, v9
    v_and_b32 v9, 0x7ff, v8
    v_lshrrev_b32 v8, 6, v8
    v_and_or_b32 v11, v10, v96, v11
    v_lshl_or_b32 v9, v10, 16, v9
    v_and_b32 v10, -32, v84
    v_and_b32 v8, -32, v8
    v_and_b32 v15, 0x7ff, v13
    v_lshrrev_b32 v84, 6, v13
    v_and_b32 v13, 0x7ff, v12
    v_lshrrev_b32 v12, 6, v12
    v_and_or_b32 v15, v14, v96, v15
    v_lshl_or_b32 v13, v14, 16, v13
    v_and_b32 v14, -32, v84
    v_and_b32 v12, -32, v12
    v_and_b32 v19, 0x7ff, v17
    v_lshrrev_b32 v84, 6, v17
    v_and_b32 v17, 0x7ff, v16
    v_lshrrev_b32 v16, 6, v16
    v_and_or_b32 v19, v18, v96, v19
    v_lshl_or_b32 v17, v18, 16, v17
    v_and_b32 v18, -32, v84
    v_and_b32 v16, -32, v16
    v_and_b32 v23, 0x7ff, v21
    v_lshrrev_b32 v84, 6, v21
    v_and_b32 v21, 0x7ff, v20
    v_lshrrev_b32 v20, 6, v20
    v_and_or_b32 v23, v22, v96, v23
    v_lshl_or_b32 v21, v22, 16, v21
    v_and_b32 v22, -32, v84
    v_and_b32 v20, -32, v20
    s_cmp_eq_u32 s81, 0
    s_cbranch_scc1 KB_CONV0
    v_and_b32 v27, 0x7ff, v25
    v_lshrrev_b32 v84, 6, v25
    v_and_b32 v25, 0x7ff, v24
    v_lshrrev_b32 v24, 6, v24
    v_and_or_b32 v27, v26, v96, v27
    v_lshl_or_b32 v25, v26, 16, v25
    v_and_b32 v26, -32, v84
    v_and_b32 v24, -32, v24
KB_CONV0:
    v_mov_b32 v84, 0
    s_mov_b32 s76, 0x200000
KB_WAIT_SCAN0:
    ds_read_b32 v87, v84 offset:6160
    ds_read_b32 v86, v84 offset:6144
    s_sub_u32 s76, s76, 1
    s_cbranch_scc1 K_END
    s_waitcnt lgkmcnt(0)
    v_readfirstlane_b32 s75, v87
    v_readfirstlane_b32 s74, v86
    s_bitcmp1_b32 s75, 31
    s_cbranch_scc0 KB_WAIT_SCAN0
    s_bitset0_b32 s75, 31
    s_mov_b32 s83, s75
    s_cmp_gt_u32 s74, 3072
    s_cbranch_scc1 KB_UNSORTED
    s_sub_u32 s75, s75, 32768
    s_cmp_gt_u32 s75, 16384
    s_cbranch_scc1 KB_UNSORTED
    ds_read_b32 v64, v64
    ds_read_b32 v65, v65
    ds_read_b32 v66, v66
    ds_read_b32 v67, v67
    ds_read_b32 v68, v68
    ds_read_b32 v69, v69
    ds_read_b32 v70, v70
    ds_read_b32 v71, v71
    s_cmp_eq_u32 s81, 0
    s_cbranch_scc1 KB_BASES0
    ds_read_b32 v72, v72
    ds_read_b32 v73, v73
KB_BASES0:
    s_waitcnt lgkmcnt(0)
    v_add_u32 v64, v64, v74
    v_cmpx_ne_u32 vcc, 0, v8
    ds_write_b64 v64, v[8:9]
    s_mov_b64 exec, -1
    v_add_u32 v65, v65, v75
    v_cmpx_ne_u32 vcc, 0, v10
    ds_write_b64 v65, v[10:11]
    s_mov_b64 exec, -1
    v_add_u32 v66, v66, v76
    v_cmpx_ne_u32 vcc, 0, v12
    ds_write_b64 v66, v[12:13]
    s_mov_b64 exec, -1
    v_add_u32 v67, v67, v77
    v_cmpx_ne_u32 vcc, 0, v14
    ds_write_b64 v67, v[14:15]
    s_mov_b64 exec, -1
    v_add_u32 v68, v68, v78
    v_cmpx_ne_u32 vcc, 0, v16
    ds_write_b64 v68, v[16:17]
    s_mov_b64 exec, -1
    v_add_u32 v69, v69, v79
    v_cmpx_ne_u32 vcc, 0, v18
    ds_write_b64 v69, v[18:19]
    s_mov_b64 exec, -1
    v_add_u32 v70, v70, v80
    v_cmpx_ne_u32 vcc, 0, v20
    ds_write_b64 v70, v[20:21]
    s_mov_b64 exec, -1
    v_add_u32 v71, v71, v81
    v_cmpx_ne_u32 vcc, 0, v22
    ds_write_b64 v71, v[22:23]
    s_mov_b64 exec, -1
    s_cmp_eq_u32 s81, 0
    s_cbranch_scc1 KB_SCATTERED0
    v_add_u32 v72, v72, v82
    v_cmpx_ne_u32 vcc, 0, v24
    ds_write_b64 v72, v[24:25]
    s_mov_b64 exec, -1
    v_add_u32 v73, v73, v83
    v_cmpx_ne_u32 vcc, 0, v26
    ds_write_b64 v73, v[26:27]
    s_mov_b64 exec, -1
KB_SCATTERED0:
    s_add_u32 s83, s83, 255
    s_lshr_b32 s83, s83, 8
    s_sub_u32 s83, s83, s3
    s_add_u32 s83, s83, 15
    s_lshr_b32 s83, s83, 4
    buffer_load_dwordx2 v[98:99], v97, s[52:55], 0 offen
    buffer_load_dwordx2 v[100:101], v126, s[52:55], 0 offen
    buffer_load_dwordx2 v[102:103], v127, s[52:55], 0 offen
    s_mov_b32 s86, 2
    s_mov_b32 s85, 24
    s_waitcnt lgkmcnt(0)
    s_barrier
    s_setprio 3
    ds_read_b64 v[8:9], v92 offset:0
    ds_read_b64 v[10:11], v92 offset:4096
    ds_read_b64 v[12:13], v92 offset:16384
    ds_read_b64 v[14:15], v92 offset:20480
    ds_read_b64 v[16:17], v92 offset:32768
    ds_read_b64 v[18:19], v92 offset:36864
    s_waitcnt lgkmcnt(4)
    v_add_u32_dpp v67, v8, v2 quad_perm:[0,0,2,2] row_mask:0xf bank_mask:0xf
    buffer_load_dwordx4 v[32:35], v67, s[52:55], 0 offen
    s_waitcnt vmcnt(4)
    v_lshrrev_b32 v68, 16, v48
    v_lshrrev_b32 v69, 16, v49
    v_and_b32 v68, -4, v68
    v_and_b32 v69, -4, v69
    v_cmpx_ne_u32 vcc, 0, v48
    ds_add_rtn_u32 v20, v68, v94 offset:568
    s_mov_b64 exec, -1
    v_cmpx_ne_u32 vcc, 0, v49
    ds_add_rtn_u32 v21, v69, v94 offset:568
    s_mov_b64 exec, -1
    v_lshrrev_b32 v70, 16, v52
    v_lshrrev_b32 v71, 16, v53
    v_and_b32 v70, -4, v70
    v_and_b32 v71, -4, v71
    v_cmpx_ne_u32 vcc, 0, v52
    ds_add_rtn_u32 v22, v70, v94 offset:568
    s_mov_b64 exec, -1
    v_cmpx_ne_u32 vcc, 0, v53
    ds_add_rtn_u32 v23, v71, v94 offset:568
    s_mov_b64 exec, -1
    v_lshrrev_b32 v72, 16, v56
    v_lshrrev_b32 v73, 16, v57
    v_and_b32 v72, -4, v72
    v_and_b32 v73, -4, v73
    v_cmpx_ne_u32 vcc, 0, v56
    ds_add_rtn_u32 v24, v72, v94 offset:568
    s_mov_b64 exec, -1
    v_cmpx_ne_u32 vcc, 0, v57
    ds_add_rtn_u32 v25, v73, v94 offset:568
    s_mov_b64 exec, -1
    v_lshrrev_b32 v74, 16, v60
    v_lshrrev_b32 v75, 16, v61
    v_and_b32 v74, -4, v74
    v_and_b32 v75, -4, v75
    v_cmpx_ne_u32 vcc, 0, v60
    ds_add_rtn_u32 v26, v74, v94 offset:568
    s_mov_b64 exec, -1
    v_cmpx_ne_u32 vcc, 0, v61
    ds_add_rtn_u32 v27, v75, v94 offset:568
    s_mov_b64 exec, -1
    s_cmp_eq_u32 s82, 0
    s_cbranch_scc1 KB_HISTED1
    v_lshrrev_b32 v76, 16, v88
    v_lshrrev_b32 v77, 16, v89
    v_and_b32 v76, -4, v76
    v_and_b32 v77, -4, v77
    v_cmpx_ne_u32 vcc, 0, v88
    ds_add_rtn_u32 v28, v76, v94 offset:568
    s_mov_b64 exec, -1
    v_cmpx_ne_u32 vcc, 0, v89
    ds_add_rtn_u32 v29, v77, v94 offset:568
    s_mov_b64 exec, -1
KB_HISTED1:
    s_waitcnt lgkmcnt(0)
    s_barrier
    s_cmp_lg_u32 s3, 0
    s_cbranch_scc1 KB_SCANNED1
    v_mul_u32_u24 v80, 48, v1
    ds_read_b128 v[68:71], v80 offset:3072
    ds_read_b128 v[72:75], v80 offset:3088
    ds_read_b128 v[76:79], v80 offset:3104
    v_mov_b32 v82, 0
    s_waitcnt lgkmcnt(0)
    v_add_u32 v69, v68, v69
    v_add_u32 v70, v69, v70
    v_add_u32 v71, v70, v71
    v_add_u32 v72, v71, v72
    v_add_u32 v73, v72, v73
    v_add_u32 v74, v73, v74
    v_add_u32 v75, v74, v75
    v_add_u32 v76, v75, v76
    v_add_u32 v77, v76, v77
    v_add_u32 v78, v77, v78
    v_add_u32 v79, v78, v79
    v_mov_b32 v81, v79
    s_nop 1
    v_add_u32_dpp v81, v81, v81 row_shr:1 row_mask:0xf bank_mask:0xf bound_ctrl:0
    s_nop 1
    v_add_u32_dpp v81, v81, v81 row_shr:2 row_mask:0xf bank_mask:0xf bound_ctrl:0
    s_nop 1
    v_add_u32_dpp v81, v81, v81 row_shr:4 row_mask:0xf bank_mask:0xf bound_ctrl:0
    s_nop 1
    v_add_u32_dpp v81, v81, v81 row_shr:8 row_mask:0xf bank_mask:0xf bound_ctrl:0
    s_nop 1
    v_add_u32_dpp v81, v81, v81 row_bcast:15 row_mask:0xa bank_mask:0xf
    s_nop 1
    v_add_u32_dpp v81, v81, v81 row_bcast:31 row_mask:0xc bank_mask:0xf
    s_nop 0
    v_readlane_b32 s74, v81, 63
    v_sub_u32 v81, v81, v79
    v_add_u32 v81, 88320, v81
    v_add_u32 v79, v81, v78
    v_add_u32 v78, v81, v77
    v_add_u32 v77, v81, v76
    v_add_u32 v76, v81, v75
    v_add_u32 v75, v81, v74
    v_add_u32 v74, v81, v73
    v_add_u32 v73, v81, v72
    v_add_u32 v72, v81, v71
    v_add_u32 v71, v81, v70
    v_add_u32 v70, v81, v69
    v_add_u32 v69, v81, v68
    v_mov_b32 v68, v81
    s_or_b32 s75, s74, 0x80000000
    s_min_u32 s74, s74, 49152
    s_add_u32 s74, s74, 88320
    v_mov_b32 v83, s75
    v_lshl_add_u32 v81, v1, 2, s74
    ds_write_b128 v80, v[68:71] offset:3072
    ds_write_b128 v80, v[72:75] offset:3088
    ds_write_b128 v80, v[76:79] offset:3104
    ds_write_b32 v81, v82
    ds_write_b32 v82, v83 offset:6164
KB_SCANNED1:
    v_add_u32_dpp v95, v10, v2 quad_perm:[0,0,2,2] row_mask:0xf bank_mask:0xf
    buffer_load_dwordx4 v[36:39], v95, s[52:55], 0 offen
    v_and_b32 v51, 0x7ff, v49
    v_lshrrev_b32 v84, 6, v49
    v_and_b32 v49, 0x7ff, v48
    v_lshrrev_b32 v48, 6, v48
    v_and_or_b32 v51, v50, v96, v51
    v_lshl_or_b32 v49, v50, 16, v49
    v_and_b32 v50, -32, v84
    v_and_b32 v48, -32, v48
    v_and_b32 v55, 0x7ff, v53
    v_lshrrev_b32 v84, 6, v53
    v_and_b32 v53, 0x7ff, v52
    v_lshrrev_b32 v52, 6, v52
    v_and_or_b32 v55, v54, v96, v55
    v_lshl_or_b32 v53, v54, 16, v53
    v_and_b32 v54, -32, v84
    v_and_b32 v52, -32, v52
    v_and_b32 v59, 0x7ff, v57
    v_lshrrev_b32 v84, 6, v57
    v_and_b32 v57, 0x7ff, v56
    v_lshrrev_b32 v56, 6, v56
    v_and_or_b32 v59, v58, v96, v59
    v_lshl_or_b32 v57, v58, 16, v57
    v_and_b32 v58, -32, v84
    v_and_b32 v56, -32, v56
    v_and_b32 v63, 0x7ff, v61
    v_lshrrev_b32 v84, 6, v61
    v_and_b32 v61, 0x7ff, v60
    v_lshrrev_b32 v60, 6, v60
    v_and_or_b32 v63, v62, v96, v63
    v_lshl_or_b32 v61, v62, 16, v61
    v_and_b32 v62, -32, v84
    v_and_b32 v60, -32, v60
    s_cmp_eq_u32 s82, 0
    s_cbranch_scc1 KB_CONV1
    v_and_b32 v91, 0x7ff, v89
    v_lshrrev_b32 v84, 6, v89
    v_and_b32 v89, 0x7ff, v88
    v_lshrrev_b32 v88, 6, v88
    v_and_or_b32 v91, v90, v96, v91
    v_lshl_or_b32 v89, v90, 16, v89
    v_and_b32 v90, -32, v84
    v_and_b32 v88, -32, v88
KB_CONV1:
    v_mov_b32 v80, 0
    s_mov_b32 s76, 0x200000
KB_WAIT_SCAN1:
    ds_read_b32 v81, v80 offset:6164
    s_sub_u32 s76, s76, 1
    s_cbranch_scc1 K_END
    s_waitcnt lgkmcnt(0)
    v_readfirstlane_b32 s84, v81
    s_bitcmp1_b32 s84, 31
    s_cbranch_scc0 KB_WAIT_SCAN1
    s_bitset0_b32 s84, 31
    v_lshrrev_b32 v68, 10, v48
    v_and_b32 v68, -4, v68
    ds_read_b32 v68, v68 offset:568
    v_lshrrev_b32 v69, 10, v50
    v_and_b32 v69, -4, v69
    ds_read_b32 v69, v69 offset:568
    v_lshrrev_b32 v70, 10, v52
    v_and_b32 v70, -4, v70
    ds_read_b32 v70, v70 offset:568
    v_lshrrev_b32 v71, 10, v54
    v_and_b32 v71, -4, v71
    ds_read_b32 v71, v71 offset:568
    v_lshrrev_b32 v72, 10, v56
    v_and_b32 v72, -4, v72
    ds_read_b32 v72, v72 offset:568
    v_lshrrev_b32 v73, 10, v58
    v_and_b32 v73, -4, v73
    ds_read_b32 v73, v73 offset:568
    v_lshrrev_b32 v74, 10, v60
    v_and_b32 v74, -4, v74
    ds_read_b32 v74, v74 offset:568
    v_lshrrev_b32 v75, 10, v62
    v_and_b32 v75, -4, v75
    ds_read_b32 v75, v75 offset:568
    s_cmp_eq_u32 s82, 0
    s_cbranch_scc1 KB_BASES1
    v_lshrrev_b32 v76, 10, v88
    v_and_b32 v76, -4, v76
    ds_read_b32 v76, v76 offset:568
    v_lshrrev_b32 v77, 10, v90
    v_and_b32 v77, -4, v77
    ds_read_b32 v77, v77 offset:568
KB_BASES1:
    s_waitcnt lgkmcnt(0)
    v_add_u32 v68, v68, v20
    v_cmpx_ne_u32 vcc, 0, v48
    ds_write_b64 v68, v[48:49]
    s_mov_b64 exec, -1
    v_add_u32 v69, v69, v21
    v_cmpx_ne_u32 vcc, 0, v50
    ds_write_b64 v69, v[50:51]
    s_mov_b64 exec, -1
    v_add_u32 v70, v70, v22
    v_cmpx_ne_u32 vcc, 0, v52
    ds_write_b64 v70, v[52:53]
    s_mov_b64 exec, -1
    v_add_u32 v71, v71, v23
    v_cmpx_ne_u32 vcc, 0, v54
    ds_write_b64 v71, v[54:55]
    s_mov_b64 exec, -1
    v_add_u32 v72, v72, v24
    v_cmpx_ne_u32 vcc, 0, v56
    ds_write_b64 v72, v[56:57]
    s_mov_b64 exec, -1
    v_add_u32 v73, v73, v25
    v_cmpx_ne_u32 vcc, 0, v58
    ds_write_b64 v73, v[58:59]
    s_mov_b64 exec, -1
    v_add_u32 v74, v74, v26
    v_cmpx_ne_u32 vcc, 0, v60
    ds_write_b64 v74, v[60:61]
    s_mov_b64 exec, -1
    v_add_u32 v75, v75, v27
    v_cmpx_ne_u32 vcc, 0, v62
    ds_write_b64 v75, v[62:63]
    s_mov_b64 exec, -1
    s_cmp_eq_u32 s82, 0
    s_cbranch_scc1 KB_SCATTERED1
    v_add_u32 v76, v76, v28
    v_cmpx_ne_u32 vcc, 0, v88
    ds_write_b64 v76, v[88:89]
    s_mov_b64 exec, -1
    v_add_u32 v77, v77, v29
    v_cmpx_ne_u32 vcc, 0, v90
    ds_write_b64 v77, v[90:91]
    s_mov_b64 exec, -1
KB_SCATTERED1:
    s_add_u32 s84, s84, 255
    s_lshr_b32 s84, s84, 8
    s_sub_u32 s84, s84, s3
    s_add_u32 s84, s84, 15
    s_lshr_b32 s84, s84, 4
    v_mov_b32 v81, 1
    s_mov_b64 exec, 1
    ds_add_u32 v80, v81 offset:6176
    s_mov_b64 exec, -1
    v_add_u32_dpp v67, v8, v2 quad_perm:[1,1,3,3] row_mask:0xf bank_mask:0xf
    buffer_load_dwordx4 v[40:43], v67, s[52:55], 0 offen
    s_branch KB_LOOP
KB_UNSORTED:
    buffer_load_dwordx2 v[98:99], v97, s[52:55], 0 offen
    buffer_load_dwordx2 v[100:101], v126, s[52:55], 0 offen
    buffer_load_dwordx2 v[102:103], v127, s[52:55], 0 offen
    s_waitcnt vmcnt(0)
    v_mov_b32 v60, v40
    v_mov_b32 v61, v41
    v_mov_b32 v62, v42
    v_mov_b32 v63, v43
    s_mov_b32 s86, 0
    s_mov_b32 s78, -1
    s_mov_b32 s87, 0
    s_mov_b32 s80, 0
KB_NEXT_PASS:
    s_cmp_lt_u32 s80, s87
    s_cbranch_scc1 KB_PASS
    s_add_u32 s78, s78, 1
    s_cmp_ge_u32 s78, 32
    s_cbranch_scc1 KB_DONE
    s_bfe_u32 s74, s78, 0x20002
    s_lshl_b32 s74, s74, 4
    s_and_b32 s75, s78, 3
    s_or_b32 s74, s74, s75
    s_mov_b32 s80, 0
    v_readlane_b32 s76, v60, s74
    v_readlane_b32 s87, v62, s74
    s_cmp_lt_u32 s78, 16
    s_cbranch_scc1 KB_NEXT_PASS
    v_readlane_b32 s76, v61, s74
    v_readlane_b32 s87, v63, s74
    s_nop 0
    s_branch KB_NEXT_PASS
KB_PASS:
    s_sub_u32 s85, s87, s80
    s_add_u32 s74, s76, s80
    s_add_u32 s80, s80, 256
    v_add_u32 v8, 0, v1
    v_cmp_gt_u32 vcc, s85, v8
    v_add_u32 v8, s74, v8
    s_nop 0
    v_cndmask_b32 v8, -1, v8, vcc
    buffer_load_dwordx3 v[8:10], v8, s[64:67], 0 idxen sc1
    v_add_u32 v12, 64, v1
    v_cmp_gt_u32 vcc, s85, v12
    v_add_u32 v12, s74, v12
    s_nop 0
    v_cndmask_b32 v12, -1, v12, vcc
    buffer_load_dwordx3 v[12:14], v12, s[64:67], 0 idxen sc1
    v_add_u32 v16, 128, v1
    v_cmp_gt_u32 vcc, s85, v16
    v_add_u32 v16, s74, v16
    s_nop 0
    v_cndmask_b32 v16, -1, v16, vcc
    buffer_load_dwordx3 v[16:18], v16, s[64:67], 0 idxen sc1
    v_add_u32 v20, 192, v1
    v_cmp_gt_u32 vcc, s85, v20
    v_add_u32 v20, s74, v20
    s_nop 0
    v_cndmask_b32 v20, -1, v20, vcc
    buffer_load_dwordx3 v[20:22], v20, s[64:67], 0 idxen sc1
    s_add_u32 s85, s85, 63
    s_lshr_b32 s85, s85, 6
    s_min_u32 s85, s85, 4
    s_lshl_b32 s85, s85, 2
    s_waitcnt vmcnt(0)
    v_and_b32 v11, 0x7ff, v9
    v_lshrrev_b32 v80, 6, v9
    v_and_b32 v9, 0x7ff, v8
    v_lshrrev_b32 v8, 6, v8
    v_and_or_b32 v11, v10, v96, v11
    v_lshl_or_b32 v9, v10, 16, v9
    v_and_b32 v10, -32, v80
    v_and_b32 v8, -32, v8
    v_and_b32 v15, 0x7ff, v13
    v_lshrrev_b32 v80, 6, v13
    v_and_b32 v13, 0x7ff, v12
    v_lshrrev_b32 v12, 6, v12
    v_and_or_b32 v15, v14, v96, v15
    v_lshl_or_b32 v13, v14, 16, v13
    v_and_b32 v14, -32, v80
    v_and_b32 v12, -32, v12
    v_and_b32 v19, 0x7ff, v17
    v_lshrrev_b32 v80, 6, v17
    v_and_b32 v17, 0x7ff, v16
    v_lshrrev_b32 v16, 6, v16
    v_and_or_b32 v19, v18, v96, v19
    v_lshl_or_b32 v17, v18, 16, v17
    v_and_b32 v18, -32, v80
    v_and_b32 v16, -32, v16
    v_and_b32 v23, 0x7ff, v21
    v_lshrrev_b32 v80, 6, v21
    v_and_b32 v21, 0x7ff, v20
    v_lshrrev_b32 v20, 6, v20
    v_and_or_b32 v23, v22, v96, v23
    v_lshl_or_b32 v21, v22, 16, v21
    v_and_b32 v22, -32, v80
    v_and_b32 v20, -32, v20
    s_nop 1
    v_add_u32_dpp v67, v8, v2 quad_perm:[0,0,2,2] row_mask:0xf bank_mask:0xf
    buffer_load_dwordx4 v[32:35], v67, s[52:55], 0 offen
    v_add_u32_dpp v95, v10, v2 quad_perm:[0,0,2,2] row_mask:0xf bank_mask:0xf
    buffer_load_dwordx4 v[36:39], v95, s[52:55], 0 offen
    v_add_u32_dpp v67, v8, v2 quad_perm:[1,1,3,3] row_mask:0xf bank_mask:0xf
    buffer_load_dwordx4 v[40:43], v67, s[52:55], 0 offen
KB_LOOP:
    s_setprio 2
    v_lshlrev_b32_sdwa v64, 6, v9 dst_sel:DWORD dst_unused:UNUSED_PAD src0_sel:DWORD src1_sel:WORD_0
    v_lshlrev_b32_sdwa v65, 6, v11 dst_sel:DWORD dst_unused:UNUSED_PAD src0_sel:DWORD src1_sel:WORD_0
    v_and_b32_dpp v66, v9, v96 quad_perm:[0,0,2,2] row_mask:0xf bank_mask:0xf
    v_xor_b32_dpp v68, v64, v3 quad_perm:[0,0,2,2] row_mask:0xf bank_mask:0xf
    s_waitcnt vmcnt(2)
    v_cndmask_b32 v72, v32, v34, s[70:71]
    v_cndmask_b32 v73, v33, v35, s[70:71]
    v_cndmask_b32 v74, v34, v32, s[70:71]
    v_cndmask_b32 v75, v35, v33, s[70:71]
    v_xor_b32 v69, 8, v68
    v_xor_b32 v70, 16, v68
    v_xor_b32 v71, 24, v68
    v_perm_b32 v76, v73, v72, v4
    v_perm_b32 v77, v73, v72, v5
    v_perm_b32 v78, v73, v72, v6
    v_perm_b32 v79, v73, v72, v7
    v_mul_f32 v76, v66, v76
    v_mul_f32 v77, v66, v77
    v_mul_f32 v78, v66, v78
    v_mul_f32 v79, v66, v79
    v_cvt_f64_f32 v[80:81], v76
    v_cvt_f64_f32 v[82:83], v77
    v_cvt_f64_f32 v[84:85], v78
    v_cvt_f64_f32 v[86:87], v79
    ds_add_f64 v68, v[80:81] offset:6400
    ds_add_f64 v69, v[82:83] offset:6400
    ds_add_f64 v70, v[84:85] offset:6400
    ds_add_f64 v71, v[86:87] offset:6400
    v_perm_b32 v76, v75, v74, v4
    v_perm_b32 v77, v75, v74, v5
    v_perm_b32 v78, v75, v74, v6
    v_perm_b32 v79, v75, v74, v7
    v_xor_b32 v68, 32, v68
    v_xor_b32 v69, 32, v69
    v_xor_b32 v70, 32, v70
    v_xor_b32 v71, 32, v71
    v_mul_f32 v76, v66, v76
    v_mul_f32 v77, v66, v77
    v_mul_f32 v78, v66, v78
    v_mul_f32 v79, v66, v79
    v_cvt_f64_f32 v[80:81], v76
    v_cvt_f64_f32 v[82:83], v77
    v_cvt_f64_f32 v[84:85], v78
    v_cvt_f64_f32 v[86:87], v79
    ds_add_f64 v68, v[80:81] offset:6400
    ds_add_f64 v69, v[82:83] offset:6400
    ds_add_f64 v70, v[84:85] offset:6400
    ds_add_f64 v71, v[86:87] offset:6400
    s_cmp_le_u32 s85, 1
    s_cbranch_scc1 KB_LOOPED
KB_LOOP1:
    v_add_u32_dpp v95, v10, v2 quad_perm:[1,1,3,3] row_mask:0xf bank_mask:0xf
    buffer_load_dwordx4 v[32:35], v95, s[52:55], 0 offen
    v_and_b32_dpp v66, v11, v96 quad_perm:[0,0,2,2] row_mask:0xf bank_mask:0xf
    v_xor_b32_dpp v68, v65, v3 quad_perm:[0,0,2,2] row_mask:0xf bank_mask:0xf
    s_waitcnt vmcnt(2)
    v_cndmask_b32 v72, v36, v38, s[70:71]
    v_cndmask_b32 v73, v37, v39, s[70:71]
    v_cndmask_b32 v74, v38, v36, s[70:71]
    v_cndmask_b32 v75, v39, v37, s[70:71]
    v_xor_b32 v69, 8, v68
    v_xor_b32 v70, 16, v68
    v_xor_b32 v71, 24, v68
    v_perm_b32 v76, v73, v72, v4
    v_perm_b32 v77, v73, v72, v5
    v_perm_b32 v78, v73, v72, v6
    v_perm_b32 v79, v73, v72, v7
    v_mul_f32 v76, v66, v76
    v_mul_f32 v77, v66, v77
    v_mul_f32 v78, v66, v78
    v_mul_f32 v79, v66, v79
    v_cvt_f64_f32 v[80:81], v76
    v_cvt_f64_f32 v[82:83], v77
    v_cvt_f64_f32 v[84:85], v78
    v_cvt_f64_f32 v[86:87], v79
    ds_add_f64 v68, v[80:81] offset:6400
    ds_add_f64 v69, v[82:83] offset:6400
    ds_add_f64 v70, v[84:85] offset:6400
    ds_add_f64 v71, v[86:87] offset:6400
    v_perm_b32 v76, v75, v74, v4
    v_perm_b32 v77, v75, v74, v5
    v_perm_b32 v78, v75, v74, v6
    v_perm_b32 v79, v75, v74, v7
    v_xor_b32 v68, 32, v68
    v_xor_b32 v69, 32, v69
    v_xor_b32 v70, 32, v70
    v_xor_b32 v71, 32, v71
    v_mul_f32 v76, v66, v76
    v_mul_f32 v77, v66, v77
    v_mul_f32 v78, v66, v78
    v_mul_f32 v79, v66, v79
    v_cvt_f64_f32 v[80:81], v76
    v_cvt_f64_f32 v[82:83], v77
    v_cvt_f64_f32 v[84:85], v78
    v_cvt_f64_f32 v[86:87], v79
    ds_add_f64 v68, v[80:81] offset:6400
    ds_add_f64 v69, v[82:83] offset:6400
    ds_add_f64 v70, v[84:85] offset:6400
    ds_add_f64 v71, v[86:87] offset:6400
    s_cmp_le_u32 s85, 2
    s_cbranch_scc1 KB_LOOPED
    v_add_u32_dpp v67, v12, v2 quad_perm:[0,0,2,2] row_mask:0xf bank_mask:0xf
    buffer_load_dwordx4 v[36:39], v67, s[52:55], 0 offen
    v_and_b32_dpp v66, v9, v96 quad_perm:[1,1,3,3] row_mask:0xf bank_mask:0xf
    v_xor_b32_dpp v68, v64, v3 quad_perm:[1,1,3,3] row_mask:0xf bank_mask:0xf
    s_waitcnt vmcnt(2)
    v_cndmask_b32 v72, v40, v42, s[70:71]
    v_cndmask_b32 v73, v41, v43, s[70:71]
    v_cndmask_b32 v74, v42, v40, s[70:71]
    v_cndmask_b32 v75, v43, v41, s[70:71]
    v_xor_b32 v69, 8, v68
    v_xor_b32 v70, 16, v68
    v_xor_b32 v71, 24, v68
    v_perm_b32 v76, v73, v72, v4
    v_perm_b32 v77, v73, v72, v5
    v_perm_b32 v78, v73, v72, v6
    v_perm_b32 v79, v73, v72, v7
    v_mul_f32 v76, v66, v76
    v_mul_f32 v77, v66, v77
    v_mul_f32 v78, v66, v78
    v_mul_f32 v79, v66, v79
    v_cvt_f64_f32 v[80:81], v76
    v_cvt_f64_f32 v[82:83], v77
    v_cvt_f64_f32 v[84:85], v78
    v_cvt_f64_f32 v[86:87], v79
    ds_add_f64 v68, v[80:81] offset:6400
    ds_add_f64 v69, v[82:83] offset:6400
    ds_add_f64 v70, v[84:85] offset:6400
    ds_add_f64 v71, v[86:87] offset:6400
    v_perm_b32 v76, v75, v74, v4
    v_perm_b32 v77, v75, v74, v5
    v_perm_b32 v78, v75, v74, v6
    v_perm_b32 v79, v75, v74, v7
    v_xor_b32 v68, 32, v68
    v_xor_b32 v69, 32, v69
    v_xor_b32 v70, 32, v70
    v_xor_b32 v71, 32, v71
    v_mul_f32 v76, v66, v76
    v_mul_f32 v77, v66, v77
    v_mul_f32 v78, v66, v78
    v_mul_f32 v79, v66, v79
    v_cvt_f64_f32 v[80:81], v76
    v_cvt_f64_f32 v[82:83], v77
    v_cvt_f64_f32 v[84:85], v78
    v_cvt_f64_f32 v[86:87], v79
    ds_add_f64 v68, v[80:81] offset:6400
    ds_add_f64 v69, v[82:83] offset:6400
    ds_add_f64 v70, v[84:85] offset:6400
    ds_add_f64 v71, v[86:87] offset:6400
    s_cmp_le_u32 s85, 3
    s_cbranch_scc1 KB_LOOPED
    v_add_u32_dpp v95, v14, v2 quad_perm:[0,0,2,2] row_mask:0xf bank_mask:0xf
    buffer_load_dwordx4 v[40:43], v95, s[52:55], 0 offen
    v_and_b32_dpp v66, v11, v96 quad_perm:[1,1,3,3] row_mask:0xf bank_mask:0xf
    v_xor_b32_dpp v68, v65, v3 quad_perm:[1,1,3,3] row_mask:0xf bank_mask:0xf
    s_waitcnt vmcnt(2)
    v_cndmask_b32 v72, v32, v34, s[70:71]
    v_cndmask_b32 v73, v33, v35, s[70:71]
    v_cndmask_b32 v74, v34, v32, s[70:71]
    v_cndmask_b32 v75, v35, v33, s[70:71]
    v_xor_b32 v69, 8, v68
    v_xor_b32 v70, 16, v68
    v_xor_b32 v71, 24, v68
    v_perm_b32 v76, v73, v72, v4
    v_perm_b32 v77, v73, v72, v5
    v_perm_b32 v78, v73, v72, v6
    v_perm_b32 v79, v73, v72, v7
    v_mul_f32 v76, v66, v76
    v_mul_f32 v77, v66, v77
    v_mul_f32 v78, v66, v78
    v_mul_f32 v79, v66, v79
    v_cvt_f64_f32 v[80:81], v76
    v_cvt_f64_f32 v[82:83], v77
    v_cvt_f64_f32 v[84:85], v78
    v_cvt_f64_f32 v[86:87], v79
    ds_add_f64 v68, v[80:81] offset:6400
    ds_add_f64 v69, v[82:83] offset:6400
    ds_add_f64 v70, v[84:85] offset:6400
    ds_add_f64 v71, v[86:87] offset:6400
    v_perm_b32 v76, v75, v74, v4
    v_perm_b32 v77, v75, v74, v5
    v_perm_b32 v78, v75, v74, v6
    v_perm_b32 v79, v75, v74, v7
    v_xor_b32 v68, 32, v68
    v_xor_b32 v69, 32, v69
    v_xor_b32 v70, 32, v70
    v_xor_b32 v71, 32, v71
    v_mul_f32 v76, v66, v76
    v_mul_f32 v77, v66, v77
    v_mul_f32 v78, v66, v78
    v_mul_f32 v79, v66, v79
    v_cvt_f64_f32 v[80:81], v76
    v_cvt_f64_f32 v[82:83], v77
    v_cvt_f64_f32 v[84:85], v78
    v_cvt_f64_f32 v[86:87], v79
    ds_add_f64 v68, v[80:81] offset:6400
    ds_add_f64 v69, v[82:83] offset:6400
    ds_add_f64 v70, v[84:85] offset:6400
    ds_add_f64 v71, v[86:87] offset:6400
    s_cmp_lg_u32 s86, 2
    s_cbranch_scc1 KB_STAGED0
    s_lshl_b32 s74, s83, 12
    s_add_u32 s85, s83, s84
    v_subrev_u32 v80, s74, v92
    v_subrev_u32 v82, s83, v93
    v_add_u32 v81, 0x10000, v80
    v_mov_b32 v83, 0
    s_mov_b32 s75, 0x200000
KB_WAIT_SORTED:
    ds_read_b32 v84, v83 offset:6176
    s_sub_u32 s75, s75, 1
    s_cbranch_scc1 K_END
    s_waitcnt lgkmcnt(0)
    v_readfirstlane_b32 s74, v84
    s_nop 0
    s_cmp_lt_u32 s74, 16
    s_cbranch_scc1 KB_WAIT_SORTED
    v_cmpx_le_i32 vcc, -8, v82
    ds_read_b64 v[16:17], v80 offset:32768
    s_mov_b64 exec, -1
    v_cmpx_le_i32 vcc, -9, v82
    ds_read_b64 v[18:19], v80 offset:36864
    s_mov_b64 exec, -1
    v_cmpx_le_i32 vcc, -12, v82
    ds_read_b64 v[20:21], v80 offset:49152
    s_mov_b64 exec, -1
    v_cmpx_le_i32 vcc, -13, v82
    ds_read_b64 v[22:23], v80 offset:53248
    s_mov_b64 exec, -1
    v_cmpx_le_i32 vcc, -16, v82
    ds_read_b64 v[24:25], v81 offset:0
    s_mov_b64 exec, -1
    v_cmpx_le_i32 vcc, -17, v82
    ds_read_b64 v[26:27], v81 offset:4096
    s_mov_b64 exec, -1
    v_cmpx_le_i32 vcc, -20, v82
    ds_read_b64 v[28:29], v81 offset:16384
    s_mov_b64 exec, -1
    v_cmpx_le_i32 vcc, -21, v82
    ds_read_b64 v[30:31], v81 offset:20480
    s_mov_b64 exec, -1
    s_nop 2
KB_STAGED0:
    s_cmp_le_u32 s85, 4
    s_cbranch_scc1 KB_LOOPED
    v_add_u32_dpp v67, v12, v2 quad_perm:[1,1,3,3] row_mask:0xf bank_mask:0xf
    buffer_load_dwordx4 v[32:35], v67, s[52:55], 0 offen
    v_lshlrev_b32_sdwa v64, 6, v13 dst_sel:DWORD dst_unused:UNUSED_PAD src0_sel:DWORD src1_sel:WORD_0
    v_lshlrev_b32_sdwa v65, 6, v15 dst_sel:DWORD dst_unused:UNUSED_PAD src0_sel:DWORD src1_sel:WORD_0
    v_and_b32_dpp v66, v13, v96 quad_perm:[0,0,2,2] row_mask:0xf bank_mask:0xf
    v_xor_b32_dpp v68, v64, v3 quad_perm:[0,0,2,2] row_mask:0xf bank_mask:0xf
    s_waitcnt vmcnt(2)
    v_cndmask_b32 v72, v36, v38, s[70:71]
    v_cndmask_b32 v73, v37, v39, s[70:71]
    v_cndmask_b32 v74, v38, v36, s[70:71]
    v_cndmask_b32 v75, v39, v37, s[70:71]
    v_xor_b32 v69, 8, v68
    v_xor_b32 v70, 16, v68
    v_xor_b32 v71, 24, v68
    v_perm_b32 v76, v73, v72, v4
    v_perm_b32 v77, v73, v72, v5
    v_perm_b32 v78, v73, v72, v6
    v_perm_b32 v79, v73, v72, v7
    v_mul_f32 v76, v66, v76
    v_mul_f32 v77, v66, v77
    v_mul_f32 v78, v66, v78
    v_mul_f32 v79, v66, v79
    v_cvt_f64_f32 v[80:81], v76
    v_cvt_f64_f32 v[82:83], v77
    v_cvt_f64_f32 v[84:85], v78
    v_cvt_f64_f32 v[86:87], v79
    ds_add_f64 v68, v[80:81] offset:6400
    ds_add_f64 v69, v[82:83] offset:6400
    ds_add_f64 v70, v[84:85] offset:6400
    ds_add_f64 v71, v[86:87] offset:6400
    v_perm_b32 v76, v75, v74, v4
    v_perm_b32 v77, v75, v74, v5
    v_perm_b32 v78, v75, v74, v6
    v_perm_b32 v79, v75, v74, v7
    v_xor_b32 v68, 32, v68
    v_xor_b32 v69, 32, v69
    v_xor_b32 v70, 32, v70
    v_xor_b32 v71, 32, v71
    v_mul_f32 v76, v66, v76
    v_mul_f32 v77, v66, v77
    v_mul_f32 v78, v66, v78
    v_mul_f32 v79, v66, v79
    v_cvt_f64_f32 v[80:81], v76
    v_cvt_f64_f32 v[82:83], v77
    v_cvt_f64_f32 v[84:85], v78
    v_cvt_f64_f32 v[86:87], v79
    ds_add_f64 v68, v[80:81] offset:6400
    ds_add_f64 v69, v[82:83] offset:6400
    ds_add_f64 v70, v[84:85] offset:6400
    ds_add_f64 v71, v[86:87] offset:6400
    s_cmp_lg_u32 s86, 2
    s_cbranch_scc1 KB_STAGED1
    s_waitcnt lgkmcnt(0)
KB_STAGED1:
    s_cmp_le_u32 s85, 5
    s_cbranch_scc1 KB_LOOPED
    v_add_u32_dpp v95, v14, v2 quad_perm:[1,1,3,3] row_mask:0xf bank_mask:0xf
    buffer_load_dwordx4 v[36:39], v95, s[52:55], 0 offen
    v_and_b32_dpp v66, v15, v96 quad_perm:[0,0,2,2] row_mask:0xf bank_mask:0xf
    v_xor_b32_dpp v68, v65, v3 quad_perm:[0,0,2,2] row_mask:0xf bank_mask:0xf
    s_waitcnt vmcnt(2)
    v_cndmask_b32 v72, v40, v42, s[70:71]
    v_cndmask_b32 v73, v41, v43, s[70:71]
    v_cndmask_b32 v74, v42, v40, s[70:71]
    v_cndmask_b32 v75, v43, v41, s[70:71]
    v_xor_b32 v69, 8, v68
    v_xor_b32 v70, 16, v68
    v_xor_b32 v71, 24, v68
    v_perm_b32 v76, v73, v72, v4
    v_perm_b32 v77, v73, v72, v5
    v_perm_b32 v78, v73, v72, v6
    v_perm_b32 v79, v73, v72, v7
    v_mul_f32 v76, v66, v76
    v_mul_f32 v77, v66, v77
    v_mul_f32 v78, v66, v78
    v_mul_f32 v79, v66, v79
    v_cvt_f64_f32 v[80:81], v76
    v_cvt_f64_f32 v[82:83], v77
    v_cvt_f64_f32 v[84:85], v78
    v_cvt_f64_f32 v[86:87], v79
    ds_add_f64 v68, v[80:81] offset:6400
    ds_add_f64 v69, v[82:83] offset:6400
    ds_add_f64 v70, v[84:85] offset:6400
    ds_add_f64 v71, v[86:87] offset:6400
    v_perm_b32 v76, v75, v74, v4
    v_perm_b32 v77, v75, v74, v5
    v_perm_b32 v78, v75, v74, v6
    v_perm_b32 v79, v75, v74, v7
    v_xor_b32 v68, 32, v68
    v_xor_b32 v69, 32, v69
    v_xor_b32 v70, 32, v70
    v_xor_b32 v71, 32, v71
    v_mul_f32 v76, v66, v76
    v_mul_f32 v77, v66, v77
    v_mul_f32 v78, v66, v78
    v_mul_f32 v79, v66, v79
    v_cvt_f64_f32 v[80:81], v76
    v_cvt_f64_f32 v[82:83], v77
    v_cvt_f64_f32 v[84:85], v78
    v_cvt_f64_f32 v[86:87], v79
    ds_add_f64 v68, v[80:81] offset:6400
    ds_add_f64 v69, v[82:83] offset:6400
    ds_add_f64 v70, v[84:85] offset:6400
    ds_add_f64 v71, v[86:87] offset:6400
    s_cmp_le_u32 s85, 6
    s_cbranch_scc1 KB_LOOPED
    v_add_u32_dpp v67, v16, v2 quad_perm:[0,0,2,2] row_mask:0xf bank_mask:0xf
    buffer_load_dwordx4 v[40:43], v67, s[52:55], 0 offen
    v_and_b32_dpp v66, v13, v96 quad_perm:[1,1,3,3] row_mask:0xf bank_mask:0xf
    v_xor_b32_dpp v68, v64, v3 quad_perm:[1,1,3,3] row_mask:0xf bank_mask:0xf
    s_waitcnt vmcnt(2)
    v_cndmask_b32 v72, v32, v34, s[70:71]
    v_cndmask_b32 v73, v33, v35, s[70:71]
    v_cndmask_b32 v74, v34, v32, s[70:71]
    v_cndmask_b32 v75, v35, v33, s[70:71]
    v_xor_b32 v69, 8, v68
    v_xor_b32 v70, 16, v68
    v_xor_b32 v71, 24, v68
    v_perm_b32 v76, v73, v72, v4
    v_perm_b32 v77, v73, v72, v5
    v_perm_b32 v78, v73, v72, v6
    v_perm_b32 v79, v73, v72, v7
    v_mul_f32 v76, v66, v76
    v_mul_f32 v77, v66, v77
    v_mul_f32 v78, v66, v78
    v_mul_f32 v79, v66, v79
    v_cvt_f64_f32 v[80:81], v76
    v_cvt_f64_f32 v[82:83], v77
    v_cvt_f64_f32 v[84:85], v78
    v_cvt_f64_f32 v[86:87], v79
    ds_add_f64 v68, v[80:81] offset:6400
    ds_add_f64 v69, v[82:83] offset:6400
    ds_add_f64 v70, v[84:85] offset:6400
    ds_add_f64 v71, v[86:87] offset:6400
    v_perm_b32 v76, v75, v74, v4
    v_perm_b32 v77, v75, v74, v5
    v_perm_b32 v78, v75, v74, v6
    v_perm_b32 v79, v75, v74, v7
    v_xor_b32 v68, 32, v68
    v_xor_b32 v69, 32, v69
    v_xor_b32 v70, 32, v70
    v_xor_b32 v71, 32, v71
    v_mul_f32 v76, v66, v76
    v_mul_f32 v77, v66, v77
    v_mul_f32 v78, v66, v78
    v_mul_f32 v79, v66, v79
    v_cvt_f64_f32 v[80:81], v76
    v_cvt_f64_f32 v[82:83], v77
    v_cvt_f64_f32 v[84:85], v78
    v_cvt_f64_f32 v[86:87], v79
    ds_add_f64 v68, v[80:81] offset:6400
    ds_add_f64 v69, v[82:83] offset:6400
    ds_add_f64 v70, v[84:85] offset:6400
    ds_add_f64 v71, v[86:87] offset:6400
    s_cmp_le_u32 s85, 7
    s_cbranch_scc1 KB_LOOPED
    s_setprio 1
    v_add_u32_dpp v95, v18, v2 quad_perm:[0,0,2,2] row_mask:0xf bank_mask:0xf
    buffer_load_dwordx4 v[32:35], v95, s[52:55], 0 offen
    v_and_b32_dpp v66, v15, v96 quad_perm:[1,1,3,3] row_mask:0xf bank_mask:0xf
    v_xor_b32_dpp v68, v65, v3 quad_perm:[1,1,3,3] row_mask:0xf bank_mask:0xf
    s_waitcnt vmcnt(2)
    v_cndmask_b32 v72, v36, v38, s[70:71]
    v_cndmask_b32 v73, v37, v39, s[70:71]
    v_cndmask_b32 v74, v38, v36, s[70:71]
    v_cndmask_b32 v75, v39, v37, s[70:71]
    v_xor_b32 v69, 8, v68
    v_xor_b32 v70, 16, v68
    v_xor_b32 v71, 24, v68
    v_perm_b32 v76, v73, v72, v4
    v_perm_b32 v77, v73, v72, v5
    v_perm_b32 v78, v73, v72, v6
    v_perm_b32 v79, v73, v72, v7
    v_mul_f32 v76, v66, v76
    v_mul_f32 v77, v66, v77
    v_mul_f32 v78, v66, v78
    v_mul_f32 v79, v66, v79
    v_cvt_f64_f32 v[80:81], v76
    v_cvt_f64_f32 v[82:83], v77
    v_cvt_f64_f32 v[84:85], v78
    v_cvt_f64_f32 v[86:87], v79
    ds_add_f64 v68, v[80:81] offset:6400
    ds_add_f64 v69, v[82:83] offset:6400
    ds_add_f64 v70, v[84:85] offset:6400
    ds_add_f64 v71, v[86:87] offset:6400
    v_perm_b32 v76, v75, v74, v4
    v_perm_b32 v77, v75, v74, v5
    v_perm_b32 v78, v75, v74, v6
    v_perm_b32 v79, v75, v74, v7
    v_xor_b32 v68, 32, v68
    v_xor_b32 v69, 32, v69
    v_xor_b32 v70, 32, v70
    v_xor_b32 v71, 32, v71
    v_mul_f32 v76, v66, v76
    v_mul_f32 v77, v66, v77
    v_mul_f32 v78, v66, v78
    v_mul_f32 v79, v66, v79
    v_cvt_f64_f32 v[80:81], v76
    v_cvt_f64_f32 v[82:83], v77
    v_cvt_f64_f32 v[84:85], v78
    v_cvt_f64_f32 v[86:87], v79
    ds_add_f64 v68, v[80:81] offset:6400
    ds_add_f64 v69, v[82:83] offset:6400
    ds_add_f64 v70, v[84:85] offset:6400
    ds_add_f64 v71, v[86:87] offset:6400
    s_cmp_le_u32 s85, 8
    s_cbranch_scc1 KB_LOOPED
    v_add_u32_dpp v67, v16, v2 quad_perm:[1,1,3,3] row_mask:0xf bank_mask:0xf
    buffer_load_dwordx4 v[36:39], v67, s[52:55], 0 offen
    v_lshlrev_b32_sdwa v64, 6, v17 dst_sel:DWORD dst_unused:UNUSED_PAD src0_sel:DWORD src1_sel:WORD_0
    v_lshlrev_b32_sdwa v65, 6, v19 dst_sel:DWORD dst_unused:UNUSED_PAD src0_sel:DWORD src1_sel:WORD_0
    v_and_b32_dpp v66, v17, v96 quad_perm:[0,0,2,2] row_mask:0xf bank_mask:0xf
    v_xor_b32_dpp v68, v64, v3 quad_perm:[0,0,2,2] row_mask:0xf bank_mask:0xf
    s_waitcnt vmcnt(2)
    v_cndmask_b32 v72, v40, v42, s[70:71]
    v_cndmask_b32 v73, v41, v43, s[70:71]
    v_cndmask_b32 v74, v42, v40, s[70:71]
    v_cndmask_b32 v75, v43, v41, s[70:71]
    v_xor_b32 v69, 8, v68
    v_xor_b32 v70, 16, v68
    v_xor_b32 v71, 24, v68
    v_perm_b32 v76, v73, v72, v4
    v_perm_b32 v77, v73, v72, v5
    v_perm_b32 v78, v73, v72, v6
    v_perm_b32 v79, v73, v72, v7
    v_mul_f32 v76, v66, v76
    v_mul_f32 v77, v66, v77
    v_mul_f32 v78, v66, v78
    v_mul_f32 v79, v66, v79
    v_cvt_f64_f32 v[80:81], v76
    v_cvt_f64_f32 v[82:83], v77
    v_cvt_f64_f32 v[84:85], v78
    v_cvt_f64_f32 v[86:87], v79
    ds_add_f64 v68, v[80:81] offset:6400
    ds_add_f64 v69, v[82:83] offset:6400
    ds_add_f64 v70, v[84:85] offset:6400
    ds_add_f64 v71, v[86:87] offset:6400
    v_perm_b32 v76, v75, v74, v4
    v_perm_b32 v77, v75, v74, v5
    v_perm_b32 v78, v75, v74, v6
    v_perm_b32 v79, v75, v74, v7
    v_xor_b32 v68, 32, v68
    v_xor_b32 v69, 32, v69
    v_xor_b32 v70, 32, v70
    v_xor_b32 v71, 32, v71
    v_mul_f32 v76, v66, v76
    v_mul_f32 v77, v66, v77
    v_mul_f32 v78, v66, v78
    v_mul_f32 v79, v66, v79
    v_cvt_f64_f32 v[80:81], v76
    v_cvt_f64_f32 v[82:83], v77
    v_cvt_f64_f32 v[84:85], v78
    v_cvt_f64_f32 v[86:87], v79
    ds_add_f64 v68, v[80:81] offset:6400
    ds_add_f64 v69, v[82:83] offset:6400
    ds_add_f64 v70, v[84:85] offset:6400
    ds_add_f64 v71, v[86:87] offset:6400
    s_cmp_le_u32 s85, 9
    s_cbranch_scc1 KB_LOOPED
    v_add_u32_dpp v95, v18, v2 quad_perm:[1,1,3,3] row_mask:0xf bank_mask:0xf
    buffer_load_dwordx4 v[40:43], v95, s[52:55], 0 offen
    v_and_b32_dpp v66, v19, v96 quad_perm:[0,0,2,2] row_mask:0xf bank_mask:0xf
    v_xor_b32_dpp v68, v65, v3 quad_perm:[0,0,2,2] row_mask:0xf bank_mask:0xf
    s_waitcnt vmcnt(2)
    v_cndmask_b32 v72, v32, v34, s[70:71]
    v_cndmask_b32 v73, v33, v35, s[70:71]
    v_cndmask_b32 v74, v34, v32, s[70:71]
    v_cndmask_b32 v75, v35, v33, s[70:71]
    v_xor_b32 v69, 8, v68
    v_xor_b32 v70, 16, v68
    v_xor_b32 v71, 24, v68
    v_perm_b32 v76, v73, v72, v4
    v_perm_b32 v77, v73, v72, v5
    v_perm_b32 v78, v73, v72, v6
    v_perm_b32 v79, v73, v72, v7
    v_mul_f32 v76, v66, v76
    v_mul_f32 v77, v66, v77
    v_mul_f32 v78, v66, v78
    v_mul_f32 v79, v66, v79
    v_cvt_f64_f32 v[80:81], v76
    v_cvt_f64_f32 v[82:83], v77
    v_cvt_f64_f32 v[84:85], v78
    v_cvt_f64_f32 v[86:87], v79
    ds_add_f64 v68, v[80:81] offset:6400
    ds_add_f64 v69, v[82:83] offset:6400
    ds_add_f64 v70, v[84:85] offset:6400
    ds_add_f64 v71, v[86:87] offset:6400
    v_perm_b32 v76, v75, v74, v4
    v_perm_b32 v77, v75, v74, v5
    v_perm_b32 v78, v75, v74, v6
    v_perm_b32 v79, v75, v74, v7
    v_xor_b32 v68, 32, v68
    v_xor_b32 v69, 32, v69
    v_xor_b32 v70, 32, v70
    v_xor_b32 v71, 32, v71
    v_mul_f32 v76, v66, v76
    v_mul_f32 v77, v66, v77
    v_mul_f32 v78, v66, v78
    v_mul_f32 v79, v66, v79
    v_cvt_f64_f32 v[80:81], v76
    v_cvt_f64_f32 v[82:83], v77
    v_cvt_f64_f32 v[84:85], v78
    v_cvt_f64_f32 v[86:87], v79
    ds_add_f64 v68, v[80:81] offset:6400
    ds_add_f64 v69, v[82:83] offset:6400
    ds_add_f64 v70, v[84:85] offset:6400
    ds_add_f64 v71, v[86:87] offset:6400
    s_cmp_le_u32 s85, 10
    s_cbranch_scc1 KB_LOOPED
    v_add_u32_dpp v67, v20, v2 quad_perm:[0,0,2,2] row_mask:0xf bank_mask:0xf
    buffer_load_dwordx4 v[32:35], v67, s[52:55], 0 offen
    v_and_b32_dpp v66, v17, v96 quad_perm:[1,1,3,3] row_mask:0xf bank_mask:0xf
    v_xor_b32_dpp v68, v64, v3 quad_perm:[1,1,3,3] row_mask:0xf bank_mask:0xf
    s_waitcnt vmcnt(2)
    v_cndmask_b32 v72, v36, v38, s[70:71]
    v_cndmask_b32 v73, v37, v39, s[70:71]
    v_cndmask_b32 v74, v38, v36, s[70:71]
    v_cndmask_b32 v75, v39, v37, s[70:71]
    v_xor_b32 v69, 8, v68
    v_xor_b32 v70, 16, v68
    v_xor_b32 v71, 24, v68
    v_perm_b32 v76, v73, v72, v4
    v_perm_b32 v77, v73, v72, v5
    v_perm_b32 v78, v73, v72, v6
    v_perm_b32 v79, v73, v72, v7
    v_mul_f32 v76, v66, v76
    v_mul_f32 v77, v66, v77
    v_mul_f32 v78, v66, v78
    v_mul_f32 v79, v66, v79
    v_cvt_f64_f32 v[80:81], v76
    v_cvt_f64_f32 v[82:83], v77
    v_cvt_f64_f32 v[84:85], v78
    v_cvt_f64_f32 v[86:87], v79
    ds_add_f64 v68, v[80:81] offset:6400
    ds_add_f64 v69, v[82:83] offset:6400
    ds_add_f64 v70, v[84:85] offset:6400
    ds_add_f64 v71, v[86:87] offset:6400
    v_perm_b32 v76, v75, v74, v4
    v_perm_b32 v77, v75, v74, v5
    v_perm_b32 v78, v75, v74, v6
    v_perm_b32 v79, v75, v74, v7
    v_xor_b32 v68, 32, v68
    v_xor_b32 v69, 32, v69
    v_xor_b32 v70, 32, v70
    v_xor_b32 v71, 32, v71
    v_mul_f32 v76, v66, v76
    v_mul_f32 v77, v66, v77
    v_mul_f32 v78, v66, v78
    v_mul_f32 v79, v66, v79
    v_cvt_f64_f32 v[80:81], v76
    v_cvt_f64_f32 v[82:83], v77
    v_cvt_f64_f32 v[84:85], v78
    v_cvt_f64_f32 v[86:87], v79
    ds_add_f64 v68, v[80:81] offset:6400
    ds_add_f64 v69, v[82:83] offset:6400
    ds_add_f64 v70, v[84:85] offset:6400
    ds_add_f64 v71, v[86:87] offset:6400
    s_cmp_le_u32 s85, 11
    s_cbranch_scc1 KB_LOOPED
    v_add_u32_dpp v95, v22, v2 quad_perm:[0,0,2,2] row_mask:0xf bank_mask:0xf
    buffer_load_dwordx4 v[36:39], v95, s[52:55], 0 offen
    v_and_b32_dpp v66, v19, v96 quad_perm:[1,1,3,3] row_mask:0xf bank_mask:0xf
    v_xor_b32_dpp v68, v65, v3 quad_perm:[1,1,3,3] row_mask:0xf bank_mask:0xf
    s_waitcnt vmcnt(2)
    v_cndmask_b32 v72, v40, v42, s[70:71]
    v_cndmask_b32 v73, v41, v43, s[70:71]
    v_cndmask_b32 v74, v42, v40, s[70:71]
    v_cndmask_b32 v75, v43, v41, s[70:71]
    v_xor_b32 v69, 8, v68
    v_xor_b32 v70, 16, v68
    v_xor_b32 v71, 24, v68
    v_perm_b32 v76, v73, v72, v4
    v_perm_b32 v77, v73, v72, v5
    v_perm_b32 v78, v73, v72, v6
    v_perm_b32 v79, v73, v72, v7
    v_mul_f32 v76, v66, v76
    v_mul_f32 v77, v66, v77
    v_mul_f32 v78, v66, v78
    v_mul_f32 v79, v66, v79
    v_cvt_f64_f32 v[80:81], v76
    v_cvt_f64_f32 v[82:83], v77
    v_cvt_f64_f32 v[84:85], v78
    v_cvt_f64_f32 v[86:87], v79
    ds_add_f64 v68, v[80:81] offset:6400
    ds_add_f64 v69, v[82:83] offset:6400
    ds_add_f64 v70, v[84:85] offset:6400
    ds_add_f64 v71, v[86:87] offset:6400
    v_perm_b32 v76, v75, v74, v4
    v_perm_b32 v77, v75, v74, v5
    v_perm_b32 v78, v75, v74, v6
    v_perm_b32 v79, v75, v74, v7
    v_xor_b32 v68, 32, v68
    v_xor_b32 v69, 32, v69
    v_xor_b32 v70, 32, v70
    v_xor_b32 v71, 32, v71
    v_mul_f32 v76, v66, v76
    v_mul_f32 v77, v66, v77
    v_mul_f32 v78, v66, v78
    v_mul_f32 v79, v66, v79
    v_cvt_f64_f32 v[80:81], v76
    v_cvt_f64_f32 v[82:83], v77
    v_cvt_f64_f32 v[84:85], v78
    v_cvt_f64_f32 v[86:87], v79
    ds_add_f64 v68, v[80:81] offset:6400
    ds_add_f64 v69, v[82:83] offset:6400
    ds_add_f64 v70, v[84:85] offset:6400
    ds_add_f64 v71, v[86:87] offset:6400
    s_cmp_le_u32 s85, 12
    s_cbranch_scc1 KB_LOOPED
    v_add_u32_dpp v67, v20, v2 quad_perm:[1,1,3,3] row_mask:0xf bank_mask:0xf
    buffer_load_dwordx4 v[40:43], v67, s[52:55], 0 offen
    v_lshlrev_b32_sdwa v64, 6, v21 dst_sel:DWORD dst_unused:UNUSED_PAD src0_sel:DWORD src1_sel:WORD_0
    v_lshlrev_b32_sdwa v65, 6, v23 dst_sel:DWORD dst_unused:UNUSED_PAD src0_sel:DWORD src1_sel:WORD_0
    v_and_b32_dpp v66, v21, v96 quad_perm:[0,0,2,2] row_mask:0xf bank_mask:0xf
    v_xor_b32_dpp v68, v64, v3 quad_perm:[0,0,2,2] row_mask:0xf bank_mask:0xf
    s_waitcnt vmcnt(2)
    v_cndmask_b32 v72, v32, v34, s[70:71]
    v_cndmask_b32 v73, v33, v35, s[70:71]
    v_cndmask_b32 v74, v34, v32, s[70:71]
    v_cndmask_b32 v75, v35, v33, s[70:71]
    v_xor_b32 v69, 8, v68
    v_xor_b32 v70, 16, v68
    v_xor_b32 v71, 24, v68
    v_perm_b32 v76, v73, v72, v4
    v_perm_b32 v77, v73, v72, v5
    v_perm_b32 v78, v73, v72, v6
    v_perm_b32 v79, v73, v72, v7
    v_mul_f32 v76, v66, v76
    v_mul_f32 v77, v66, v77
    v_mul_f32 v78, v66, v78
    v_mul_f32 v79, v66, v79
    v_cvt_f64_f32 v[80:81], v76
    v_cvt_f64_f32 v[82:83], v77
    v_cvt_f64_f32 v[84:85], v78
    v_cvt_f64_f32 v[86:87], v79
    ds_add_f64 v68, v[80:81] offset:6400
    ds_add_f64 v69, v[82:83] offset:6400
    ds_add_f64 v70, v[84:85] offset:6400
    ds_add_f64 v71, v[86:87] offset:6400
    v_perm_b32 v76, v75, v74, v4
    v_perm_b32 v77, v75, v74, v5
    v_perm_b32 v78, v75, v74, v6
    v_perm_b32 v79, v75, v74, v7
    v_xor_b32 v68, 32, v68
    v_xor_b32 v69, 32, v69
    v_xor_b32 v70, 32, v70
    v_xor_b32 v71, 32, v71
    v_mul_f32 v76, v66, v76
    v_mul_f32 v77, v66, v77
    v_mul_f32 v78, v66, v78
    v_mul_f32 v79, v66, v79
    v_cvt_f64_f32 v[80:81], v76
    v_cvt_f64_f32 v[82:83], v77
    v_cvt_f64_f32 v[84:85], v78
    v_cvt_f64_f32 v[86:87], v79
    ds_add_f64 v68, v[80:81] offset:6400
    ds_add_f64 v69, v[82:83] offset:6400
    ds_add_f64 v70, v[84:85] offset:6400
    ds_add_f64 v71, v[86:87] offset:6400
    s_cmp_le_u32 s85, 13
    s_cbranch_scc1 KB_LOOPED
    v_add_u32_dpp v95, v22, v2 quad_perm:[1,1,3,3] row_mask:0xf bank_mask:0xf
    buffer_load_dwordx4 v[32:35], v95, s[52:55], 0 offen
    v_and_b32_dpp v66, v23, v96 quad_perm:[0,0,2,2] row_mask:0xf bank_mask:0xf
    v_xor_b32_dpp v68, v65, v3 quad_perm:[0,0,2,2] row_mask:0xf bank_mask:0xf
    s_waitcnt vmcnt(2)
    v_cndmask_b32 v72, v36, v38, s[70:71]
    v_cndmask_b32 v73, v37, v39, s[70:71]
    v_cndmask_b32 v74, v38, v36, s[70:71]
    v_cndmask_b32 v75, v39, v37, s[70:71]
    v_xor_b32 v69, 8, v68
    v_xor_b32 v70, 16, v68
    v_xor_b32 v71, 24, v68
    v_perm_b32 v76, v73, v72, v4
    v_perm_b32 v77, v73, v72, v5
    v_perm_b32 v78, v73, v72, v6
    v_perm_b32 v79, v73, v72, v7
    v_mul_f32 v76, v66, v76
    v_mul_f32 v77, v66, v77
    v_mul_f32 v78, v66, v78
    v_mul_f32 v79, v66, v79
    v_cvt_f64_f32 v[80:81], v76
    v_cvt_f64_f32 v[82:83], v77
    v_cvt_f64_f32 v[84:85], v78
    v_cvt_f64_f32 v[86:87], v79
    ds_add_f64 v68, v[80:81] offset:6400
    ds_add_f64 v69, v[82:83] offset:6400
    ds_add_f64 v70, v[84:85] offset:6400
    ds_add_f64 v71, v[86:87] offset:6400
    v_perm_b32 v76, v75, v74, v4
    v_perm_b32 v77, v75, v74, v5
    v_perm_b32 v78, v75, v74, v6
    v_perm_b32 v79, v75, v74, v7
    v_xor_b32 v68, 32, v68
    v_xor_b32 v69, 32, v69
    v_xor_b32 v70, 32, v70
    v_xor_b32 v71, 32, v71
    v_mul_f32 v76, v66, v76
    v_mul_f32 v77, v66, v77
    v_mul_f32 v78, v66, v78
    v_mul_f32 v79, v66, v79
    v_cvt_f64_f32 v[80:81], v76
    v_cvt_f64_f32 v[82:83], v77
    v_cvt_f64_f32 v[84:85], v78
    v_cvt_f64_f32 v[86:87], v79
    ds_add_f64 v68, v[80:81] offset:6400
    ds_add_f64 v69, v[82:83] offset:6400
    ds_add_f64 v70, v[84:85] offset:6400
    ds_add_f64 v71, v[86:87] offset:6400
    s_cmp_le_u32 s85, 14
    s_cbranch_scc1 KB_LOOPED
    s_setprio 0
    s_cmp_gt_u32 s85, 16
    s_cselect_b64 exec, -1, 1
    v_add_u32_dpp v67, v24, v2 quad_perm:[0,0,2,2] row_mask:0xf bank_mask:0xf
    buffer_load_dwordx4 v[36:39], v67, s[52:55], 0 offen
    s_mov_b64 exec, -1
    v_and_b32_dpp v66, v21, v96 quad_perm:[1,1,3,3] row_mask:0xf bank_mask:0xf
    v_xor_b32_dpp v68, v64, v3 quad_perm:[1,1,3,3] row_mask:0xf bank_mask:0xf
    s_waitcnt vmcnt(2)
    v_cndmask_b32 v72, v40, v42, s[70:71]
    v_cndmask_b32 v73, v41, v43, s[70:71]
    v_cndmask_b32 v74, v42, v40, s[70:71]
    v_cndmask_b32 v75, v43, v41, s[70:71]
    v_xor_b32 v69, 8, v68
    v_xor_b32 v70, 16, v68
    v_xor_b32 v71, 24, v68
    v_perm_b32 v76, v73, v72, v4
    v_perm_b32 v77, v73, v72, v5
    v_perm_b32 v78, v73, v72, v6
    v_perm_b32 v79, v73, v72, v7
    v_mul_f32 v76, v66, v76
    v_mul_f32 v77, v66, v77
    v_mul_f32 v78, v66, v78
    v_mul_f32 v79, v66, v79
    v_cvt_f64_f32 v[80:81], v76
    v_cvt_f64_f32 v[82:83], v77
    v_cvt_f64_f32 v[84:85], v78
    v_cvt_f64_f32 v[86:87], v79
    ds_add_f64 v68, v[80:81] offset:6400
    ds_add_f64 v69, v[82:83] offset:6400
    ds_add_f64 v70, v[84:85] offset:6400
    ds_add_f64 v71, v[86:87] offset:6400
    v_perm_b32 v76, v75, v74, v4
    v_perm_b32 v77, v75, v74, v5
    v_perm_b32 v78, v75, v74, v6
    v_perm_b32 v79, v75, v74, v7
    v_xor_b32 v68, 32, v68
    v_xor_b32 v69, 32, v69
    v_xor_b32 v70, 32, v70
    v_xor_b32 v71, 32, v71
    v_mul_f32 v76, v66, v76
    v_mul_f32 v77, v66, v77
    v_mul_f32 v78, v66, v78
    v_mul_f32 v79, v66, v79
    v_cvt_f64_f32 v[80:81], v76
    v_cvt_f64_f32 v[82:83], v77
    v_cvt_f64_f32 v[84:85], v78
    v_cvt_f64_f32 v[86:87], v79
    ds_add_f64 v68, v[80:81] offset:6400
    ds_add_f64 v69, v[82:83] offset:6400
    ds_add_f64 v70, v[84:85] offset:6400
    ds_add_f64 v71, v[86:87] offset:6400
    s_cmp_le_u32 s85, 15
    s_cbranch_scc1 KB_LOOPED
    s_cmp_gt_u32 s85, 17
    s_cselect_b64 exec, -1, 1
    v_add_u32_dpp v95, v26, v2 quad_perm:[0,0,2,2] row_mask:0xf bank_mask:0xf
    buffer_load_dwordx4 v[40:43], v95, s[52:55], 0 offen
    s_mov_b64 exec, -1
    v_and_b32_dpp v66, v23, v96 quad_perm:[1,1,3,3] row_mask:0xf bank_mask:0xf
    v_xor_b32_dpp v68, v65, v3 quad_perm:[1,1,3,3] row_mask:0xf bank_mask:0xf
    s_waitcnt vmcnt(2)
    v_cndmask_b32 v72, v32, v34, s[70:71]
    v_cndmask_b32 v73, v33, v35, s[70:71]
    v_cndmask_b32 v74, v34, v32, s[70:71]
    v_cndmask_b32 v75, v35, v33, s[70:71]
    v_xor_b32 v69, 8, v68
    v_xor_b32 v70, 16, v68
    v_xor_b32 v71, 24, v68
    v_perm_b32 v76, v73, v72, v4
    v_perm_b32 v77, v73, v72, v5
    v_perm_b32 v78, v73, v72, v6
    v_perm_b32 v79, v73, v72, v7
    v_mul_f32 v76, v66, v76
    v_mul_f32 v77, v66, v77
    v_mul_f32 v78, v66, v78
    v_mul_f32 v79, v66, v79
    v_cvt_f64_f32 v[80:81], v76
    v_cvt_f64_f32 v[82:83], v77
    v_cvt_f64_f32 v[84:85], v78
    v_cvt_f64_f32 v[86:87], v79
    ds_add_f64 v68, v[80:81] offset:6400
    ds_add_f64 v69, v[82:83] offset:6400
    ds_add_f64 v70, v[84:85] offset:6400
    ds_add_f64 v71, v[86:87] offset:6400
    v_perm_b32 v76, v75, v74, v4
    v_perm_b32 v77, v75, v74, v5
    v_perm_b32 v78, v75, v74, v6
    v_perm_b32 v79, v75, v74, v7
    v_xor_b32 v68, 32, v68
    v_xor_b32 v69, 32, v69
    v_xor_b32 v70, 32, v70
    v_xor_b32 v71, 32, v71
    v_mul_f32 v76, v66, v76
    v_mul_f32 v77, v66, v77
    v_mul_f32 v78, v66, v78
    v_mul_f32 v79, v66, v79
    v_cvt_f64_f32 v[80:81], v76
    v_cvt_f64_f32 v[82:83], v77
    v_cvt_f64_f32 v[84:85], v78
    v_cvt_f64_f32 v[86:87], v79
    ds_add_f64 v68, v[80:81] offset:6400
    ds_add_f64 v69, v[82:83] offset:6400
    ds_add_f64 v70, v[84:85] offset:6400
    ds_add_f64 v71, v[86:87] offset:6400
    s_cmp_le_u32 s85, 16
    s_cbranch_scc1 KB_LOOPED
    s_cmp_gt_u32 s85, 18
    s_cselect_b64 exec, -1, 1
    v_add_u32_dpp v67, v24, v2 quad_perm:[1,1,3,3] row_mask:0xf bank_mask:0xf
    buffer_load_dwordx4 v[32:35], v67, s[52:55], 0 offen
    s_mov_b64 exec, -1
    v_lshlrev_b32_sdwa v64, 6, v25 dst_sel:DWORD dst_unused:UNUSED_PAD src0_sel:DWORD src1_sel:WORD_0
    v_lshlrev_b32_sdwa v65, 6, v27 dst_sel:DWORD dst_unused:UNUSED_PAD src0_sel:DWORD src1_sel:WORD_0
    v_and_b32_dpp v66, v25, v96 quad_perm:[0,0,2,2] row_mask:0xf bank_mask:0xf
    v_xor_b32_dpp v68, v64, v3 quad_perm:[0,0,2,2] row_mask:0xf bank_mask:0xf
    s_waitcnt vmcnt(2)
    v_cndmask_b32 v72, v36, v38, s[70:71]
    v_cndmask_b32 v73, v37, v39, s[70:71]
    v_cndmask_b32 v74, v38, v36, s[70:71]
    v_cndmask_b32 v75, v39, v37, s[70:71]
    v_xor_b32 v69, 8, v68
    v_xor_b32 v70, 16, v68
    v_xor_b32 v71, 24, v68
    v_perm_b32 v76, v73, v72, v4
    v_perm_b32 v77, v73, v72, v5
    v_perm_b32 v78, v73, v72, v6
    v_perm_b32 v79, v73, v72, v7
    v_mul_f32 v76, v66, v76
    v_mul_f32 v77, v66, v77
    v_mul_f32 v78, v66, v78
    v_mul_f32 v79, v66, v79
    v_cvt_f64_f32 v[80:81], v76
    v_cvt_f64_f32 v[82:83], v77
    v_cvt_f64_f32 v[84:85], v78
    v_cvt_f64_f32 v[86:87], v79
    ds_add_f64 v68, v[80:81] offset:6400
    ds_add_f64 v69, v[82:83] offset:6400
    ds_add_f64 v70, v[84:85] offset:6400
    ds_add_f64 v71, v[86:87] offset:6400
    v_perm_b32 v76, v75, v74, v4
    v_perm_b32 v77, v75, v74, v5
    v_perm_b32 v78, v75, v74, v6
    v_perm_b32 v79, v75, v74, v7
    v_xor_b32 v68, 32, v68
    v_xor_b32 v69, 32, v69
    v_xor_b32 v70, 32, v70
    v_xor_b32 v71, 32, v71
    v_mul_f32 v76, v66, v76
    v_mul_f32 v77, v66, v77
    v_mul_f32 v78, v66, v78
    v_mul_f32 v79, v66, v79
    v_cvt_f64_f32 v[80:81], v76
    v_cvt_f64_f32 v[82:83], v77
    v_cvt_f64_f32 v[84:85], v78
    v_cvt_f64_f32 v[86:87], v79
    ds_add_f64 v68, v[80:81] offset:6400
    ds_add_f64 v69, v[82:83] offset:6400
    ds_add_f64 v70, v[84:85] offset:6400
    ds_add_f64 v71, v[86:87] offset:6400
    s_cmp_le_u32 s85, 17
    s_cbranch_scc1 KB_LOOPED
    s_cmp_gt_u32 s85, 19
    s_cselect_b64 exec, -1, 1
    v_add_u32_dpp v95, v26, v2 quad_perm:[1,1,3,3] row_mask:0xf bank_mask:0xf
    buffer_load_dwordx4 v[36:39], v95, s[52:55], 0 offen
    s_mov_b64 exec, -1
    v_and_b32_dpp v66, v27, v96 quad_perm:[0,0,2,2] row_mask:0xf bank_mask:0xf
    v_xor_b32_dpp v68, v65, v3 quad_perm:[0,0,2,2] row_mask:0xf bank_mask:0xf
    s_waitcnt vmcnt(2)
    v_cndmask_b32 v72, v40, v42, s[70:71]
    v_cndmask_b32 v73, v41, v43, s[70:71]
    v_cndmask_b32 v74, v42, v40, s[70:71]
    v_cndmask_b32 v75, v43, v41, s[70:71]
    v_xor_b32 v69, 8, v68
    v_xor_b32 v70, 16, v68
    v_xor_b32 v71, 24, v68
    v_perm_b32 v76, v73, v72, v4
    v_perm_b32 v77, v73, v72, v5
    v_perm_b32 v78, v73, v72, v6
    v_perm_b32 v79, v73, v72, v7
    v_mul_f32 v76, v66, v76
    v_mul_f32 v77, v66, v77
    v_mul_f32 v78, v66, v78
    v_mul_f32 v79, v66, v79
    v_cvt_f64_f32 v[80:81], v76
    v_cvt_f64_f32 v[82:83], v77
    v_cvt_f64_f32 v[84:85], v78
    v_cvt_f64_f32 v[86:87], v79
    ds_add_f64 v68, v[80:81] offset:6400
    ds_add_f64 v69, v[82:83] offset:6400
    ds_add_f64 v70, v[84:85] offset:6400
    ds_add_f64 v71, v[86:87] offset:6400
    v_perm_b32 v76, v75, v74, v4
    v_perm_b32 v77, v75, v74, v5
    v_perm_b32 v78, v75, v74, v6
    v_perm_b32 v79, v75, v74, v7
    v_xor_b32 v68, 32, v68
    v_xor_b32 v69, 32, v69
    v_xor_b32 v70, 32, v70
    v_xor_b32 v71, 32, v71
    v_mul_f32 v76, v66, v76
    v_mul_f32 v77, v66, v77
    v_mul_f32 v78, v66, v78
    v_mul_f32 v79, v66, v79
    v_cvt_f64_f32 v[80:81], v76
    v_cvt_f64_f32 v[82:83], v77
    v_cvt_f64_f32 v[84:85], v78
    v_cvt_f64_f32 v[86:87], v79
    ds_add_f64 v68, v[80:81] offset:6400
    ds_add_f64 v69, v[82:83] offset:6400
    ds_add_f64 v70, v[84:85] offset:6400
    ds_add_f64 v71, v[86:87] offset:6400
    s_cmp_le_u32 s85, 18
    s_cbranch_scc1 KB_LOOPED
    s_cmp_gt_u32 s85, 20
    s_cselect_b64 exec, -1, 1
    v_add_u32_dpp v67, v28, v2 quad_perm:[0,0,2,2] row_mask:0xf bank_mask:0xf
    buffer_load_dwordx4 v[40:43], v67, s[52:55], 0 offen
    s_mov_b64 exec, -1
    v_and_b32_dpp v66, v25, v96 quad_perm:[1,1,3,3] row_mask:0xf bank_mask:0xf
    v_xor_b32_dpp v68, v64, v3 quad_perm:[1,1,3,3] row_mask:0xf bank_mask:0xf
    s_waitcnt vmcnt(2)
    v_cndmask_b32 v72, v32, v34, s[70:71]
    v_cndmask_b32 v73, v33, v35, s[70:71]
    v_cndmask_b32 v74, v34, v32, s[70:71]
    v_cndmask_b32 v75, v35, v33, s[70:71]
    v_xor_b32 v69, 8, v68
    v_xor_b32 v70, 16, v68
    v_xor_b32 v71, 24, v68
    v_perm_b32 v76, v73, v72, v4
    v_perm_b32 v77, v73, v72, v5
    v_perm_b32 v78, v73, v72, v6
    v_perm_b32 v79, v73, v72, v7
    v_mul_f32 v76, v66, v76
    v_mul_f32 v77, v66, v77
    v_mul_f32 v78, v66, v78
    v_mul_f32 v79, v66, v79
    v_cvt_f64_f32 v[80:81], v76
    v_cvt_f64_f32 v[82:83], v77
    v_cvt_f64_f32 v[84:85], v78
    v_cvt_f64_f32 v[86:87], v79
    ds_add_f64 v68, v[80:81] offset:6400
    ds_add_f64 v69, v[82:83] offset:6400
    ds_add_f64 v70, v[84:85] offset:6400
    ds_add_f64 v71, v[86:87] offset:6400
    v_perm_b32 v76, v75, v74, v4
    v_perm_b32 v77, v75, v74, v5
    v_perm_b32 v78, v75, v74, v6
    v_perm_b32 v79, v75, v74, v7
    v_xor_b32 v68, 32, v68
    v_xor_b32 v69, 32, v69
    v_xor_b32 v70, 32, v70
    v_xor_b32 v71, 32, v71
    v_mul_f32 v76, v66, v76
    v_mul_f32 v77, v66, v77
    v_mul_f32 v78, v66, v78
    v_mul_f32 v79, v66, v79
    v_cvt_f64_f32 v[80:81], v76
    v_cvt_f64_f32 v[82:83], v77
    v_cvt_f64_f32 v[84:85], v78
    v_cvt_f64_f32 v[86:87], v79
    ds_add_f64 v68, v[80:81] offset:6400
    ds_add_f64 v69, v[82:83] offset:6400
    ds_add_f64 v70, v[84:85] offset:6400
    ds_add_f64 v71, v[86:87] offset:6400
    s_cmp_le_u32 s85, 19
    s_cbranch_scc1 KB_LOOPED
    s_cmp_gt_u32 s85, 21
    s_cselect_b64 exec, -1, 1
    v_add_u32_dpp v95, v30, v2 quad_perm:[0,0,2,2] row_mask:0xf bank_mask:0xf
    buffer_load_dwordx4 v[32:35], v95, s[52:55], 0 offen
    s_mov_b64 exec, -1
    v_and_b32_dpp v66, v27, v96 quad_perm:[1,1,3,3] row_mask:0xf bank_mask:0xf
    v_xor_b32_dpp v68, v65, v3 quad_perm:[1,1,3,3] row_mask:0xf bank_mask:0xf
    s_waitcnt vmcnt(2)
    v_cndmask_b32 v72, v36, v38, s[70:71]
    v_cndmask_b32 v73, v37, v39, s[70:71]
    v_cndmask_b32 v74, v38, v36, s[70:71]
    v_cndmask_b32 v75, v39, v37, s[70:71]
    v_xor_b32 v69, 8, v68
    v_xor_b32 v70, 16, v68
    v_xor_b32 v71, 24, v68
    v_perm_b32 v76, v73, v72, v4
    v_perm_b32 v77, v73, v72, v5
    v_perm_b32 v78, v73, v72, v6
    v_perm_b32 v79, v73, v72, v7
    v_mul_f32 v76, v66, v76
    v_mul_f32 v77, v66, v77
    v_mul_f32 v78, v66, v78
    v_mul_f32 v79, v66, v79
    v_cvt_f64_f32 v[80:81], v76
    v_cvt_f64_f32 v[82:83], v77
    v_cvt_f64_f32 v[84:85], v78
    v_cvt_f64_f32 v[86:87], v79
    ds_add_f64 v68, v[80:81] offset:6400
    ds_add_f64 v69, v[82:83] offset:6400
    ds_add_f64 v70, v[84:85] offset:6400
    ds_add_f64 v71, v[86:87] offset:6400
    v_perm_b32 v76, v75, v74, v4
    v_perm_b32 v77, v75, v74, v5
    v_perm_b32 v78, v75, v74, v6
    v_perm_b32 v79, v75, v74, v7
    v_xor_b32 v68, 32, v68
    v_xor_b32 v69, 32, v69
    v_xor_b32 v70, 32, v70
    v_xor_b32 v71, 32, v71
    v_mul_f32 v76, v66, v76
    v_mul_f32 v77, v66, v77
    v_mul_f32 v78, v66, v78
    v_mul_f32 v79, v66, v79
    v_cvt_f64_f32 v[80:81], v76
    v_cvt_f64_f32 v[82:83], v77
    v_cvt_f64_f32 v[84:85], v78
    v_cvt_f64_f32 v[86:87], v79
    ds_add_f64 v68, v[80:81] offset:6400
    ds_add_f64 v69, v[82:83] offset:6400
    ds_add_f64 v70, v[84:85] offset:6400
    ds_add_f64 v71, v[86:87] offset:6400
    s_cmp_le_u32 s85, 20
    s_cbranch_scc1 KB_LOOPED
    s_cmp_gt_u32 s85, 22
    s_cselect_b64 exec, -1, 1
    v_add_u32_dpp v67, v28, v2 quad_perm:[1,1,3,3] row_mask:0xf bank_mask:0xf
    buffer_load_dwordx4 v[36:39], v67, s[52:55], 0 offen
    s_mov_b64 exec, -1
    v_lshlrev_b32_sdwa v64, 6, v29 dst_sel:DWORD dst_unused:UNUSED_PAD src0_sel:DWORD src1_sel:WORD_0
    v_lshlrev_b32_sdwa v65, 6, v31 dst_sel:DWORD dst_unused:UNUSED_PAD src0_sel:DWORD src1_sel:WORD_0
    v_and_b32_dpp v66, v29, v96 quad_perm:[0,0,2,2] row_mask:0xf bank_mask:0xf
    v_xor_b32_dpp v68, v64, v3 quad_perm:[0,0,2,2] row_mask:0xf bank_mask:0xf
    s_waitcnt vmcnt(2)
    v_cndmask_b32 v72, v40, v42, s[70:71]
    v_cndmask_b32 v73, v41, v43, s[70:71]
    v_cndmask_b32 v74, v42, v40, s[70:71]
    v_cndmask_b32 v75, v43, v41, s[70:71]
    v_xor_b32 v69, 8, v68
    v_xor_b32 v70, 16, v68
    v_xor_b32 v71, 24, v68
    v_perm_b32 v76, v73, v72, v4
    v_perm_b32 v77, v73, v72, v5
    v_perm_b32 v78, v73, v72, v6
    v_perm_b32 v79, v73, v72, v7
    v_mul_f32 v76, v66, v76
    v_mul_f32 v77, v66, v77
    v_mul_f32 v78, v66, v78
    v_mul_f32 v79, v66, v79
    v_cvt_f64_f32 v[80:81], v76
    v_cvt_f64_f32 v[82:83], v77
    v_cvt_f64_f32 v[84:85], v78
    v_cvt_f64_f32 v[86:87], v79
    ds_add_f64 v68, v[80:81] offset:6400
    ds_add_f64 v69, v[82:83] offset:6400
    ds_add_f64 v70, v[84:85] offset:6400
    ds_add_f64 v71, v[86:87] offset:6400
    v_perm_b32 v76, v75, v74, v4
    v_perm_b32 v77, v75, v74, v5
    v_perm_b32 v78, v75, v74, v6
    v_perm_b32 v79, v75, v74, v7
    v_xor_b32 v68, 32, v68
    v_xor_b32 v69, 32, v69
    v_xor_b32 v70, 32, v70
    v_xor_b32 v71, 32, v71
    v_mul_f32 v76, v66, v76
    v_mul_f32 v77, v66, v77
    v_mul_f32 v78, v66, v78
    v_mul_f32 v79, v66, v79
    v_cvt_f64_f32 v[80:81], v76
    v_cvt_f64_f32 v[82:83], v77
    v_cvt_f64_f32 v[84:85], v78
    v_cvt_f64_f32 v[86:87], v79
    ds_add_f64 v68, v[80:81] offset:6400
    ds_add_f64 v69, v[82:83] offset:6400
    ds_add_f64 v70, v[84:85] offset:6400
    ds_add_f64 v71, v[86:87] offset:6400
    s_cmp_le_u32 s85, 21
    s_cbranch_scc1 KB_LOOPED
    s_cmp_gt_u32 s85, 23
    s_cselect_b64 exec, -1, 1
    v_add_u32_dpp v95, v30, v2 quad_perm:[1,1,3,3] row_mask:0xf bank_mask:0xf
    buffer_load_dwordx4 v[40:43], v95, s[52:55], 0 offen
    s_mov_b64 exec, -1
    v_and_b32_dpp v66, v31, v96 quad_perm:[0,0,2,2] row_mask:0xf bank_mask:0xf
    v_xor_b32_dpp v68, v65, v3 quad_perm:[0,0,2,2] row_mask:0xf bank_mask:0xf
    s_waitcnt vmcnt(2)
    v_cndmask_b32 v72, v32, v34, s[70:71]
    v_cndmask_b32 v73, v33, v35, s[70:71]
    v_cndmask_b32 v74, v34, v32, s[70:71]
    v_cndmask_b32 v75, v35, v33, s[70:71]
    v_xor_b32 v69, 8, v68
    v_xor_b32 v70, 16, v68
    v_xor_b32 v71, 24, v68
    v_perm_b32 v76, v73, v72, v4
    v_perm_b32 v77, v73, v72, v5
    v_perm_b32 v78, v73, v72, v6
    v_perm_b32 v79, v73, v72, v7
    v_mul_f32 v76, v66, v76
    v_mul_f32 v77, v66, v77
    v_mul_f32 v78, v66, v78
    v_mul_f32 v79, v66, v79
    v_cvt_f64_f32 v[80:81], v76
    v_cvt_f64_f32 v[82:83], v77
    v_cvt_f64_f32 v[84:85], v78
    v_cvt_f64_f32 v[86:87], v79
    ds_add_f64 v68, v[80:81] offset:6400
    ds_add_f64 v69, v[82:83] offset:6400
    ds_add_f64 v70, v[84:85] offset:6400
    ds_add_f64 v71, v[86:87] offset:6400
    v_perm_b32 v76, v75, v74, v4
    v_perm_b32 v77, v75, v74, v5
    v_perm_b32 v78, v75, v74, v6
    v_perm_b32 v79, v75, v74, v7
    v_xor_b32 v68, 32, v68
    v_xor_b32 v69, 32, v69
    v_xor_b32 v70, 32, v70
    v_xor_b32 v71, 32, v71
    v_mul_f32 v76, v66, v76
    v_mul_f32 v77, v66, v77
    v_mul_f32 v78, v66, v78
    v_mul_f32 v79, v66, v79
    v_cvt_f64_f32 v[80:81], v76
    v_cvt_f64_f32 v[82:83], v77
    v_cvt_f64_f32 v[84:85], v78
    v_cvt_f64_f32 v[86:87], v79
    ds_add_f64 v68, v[80:81] offset:6400
    ds_add_f64 v69, v[82:83] offset:6400
    ds_add_f64 v70, v[84:85] offset:6400
    ds_add_f64 v71, v[86:87] offset:6400
    s_cmp_le_u32 s85, 22
    s_cbranch_scc1 KB_LOOPED
    v_and_b32_dpp v66, v29, v96 quad_perm:[1,1,3,3] row_mask:0xf bank_mask:0xf
    v_xor_b32_dpp v68, v64, v3 quad_perm:[1,1,3,3] row_mask:0xf bank_mask:0xf
    s_waitcnt vmcnt(1)
    v_cndmask_b32 v72, v36, v38, s[70:71]
    v_cndmask_b32 v73, v37, v39, s[70:71]
    v_cndmask_b32 v74, v38, v36, s[70:71]
    v_cndmask_b32 v75, v39, v37, s[70:71]
    v_xor_b32 v69, 8, v68
    v_xor_b32 v70, 16, v68
    v_xor_b32 v71, 24, v68
    v_perm_b32 v76, v73, v72, v4
    v_perm_b32 v77, v73, v72, v5
    v_perm_b32 v78, v73, v72, v6
    v_perm_b32 v79, v73, v72, v7
    v_mul_f32 v76, v66, v76
    v_mul_f32 v77, v66, v77
    v_mul_f32 v78, v66, v78
    v_mul_f32 v79, v66, v79
    v_cvt_f64_f32 v[80:81], v76
    v_cvt_f64_f32 v[82:83], v77
    v_cvt_f64_f32 v[84:85], v78
    v_cvt_f64_f32 v[86:87], v79
    ds_add_f64 v68, v[80:81] offset:6400
    ds_add_f64 v69, v[82:83] offset:6400
    ds_add_f64 v70, v[84:85] offset:6400
    ds_add_f64 v71, v[86:87] offset:6400
    v_perm_b32 v76, v75, v74, v4
    v_perm_b32 v77, v75, v74, v5
    v_perm_b32 v78, v75, v74, v6
    v_perm_b32 v79, v75, v74, v7
    v_xor_b32 v68, 32, v68
    v_xor_b32 v69, 32, v69
    v_xor_b32 v70, 32, v70
    v_xor_b32 v71, 32, v71
    v_mul_f32 v76, v66, v76
    v_mul_f32 v77, v66, v77
    v_mul_f32 v78, v66, v78
    v_mul_f32 v79, v66, v79
    v_cvt_f64_f32 v[80:81], v76
    v_cvt_f64_f32 v[82:83], v77
    v_cvt_f64_f32 v[84:85], v78
    v_cvt_f64_f32 v[86:87], v79
    ds_add_f64 v68, v[80:81] offset:6400
    ds_add_f64 v69, v[82:83] offset:6400
    ds_add_f64 v70, v[84:85] offset:6400
    ds_add_f64 v71, v[86:87] offset:6400
    s_cmp_le_u32 s85, 23
    s_cbranch_scc1 KB_LOOPED
    v_and_b32_dpp v66, v31, v96 quad_perm:[1,1,3,3] row_mask:0xf bank_mask:0xf
    v_xor_b32_dpp v68, v65, v3 quad_perm:[1,1,3,3] row_mask:0xf bank_mask:0xf
    s_waitcnt vmcnt(0)
    v_cndmask_b32 v72, v40, v42, s[70:71]
    v_cndmask_b32 v73, v41, v43, s[70:71]
    v_cndmask_b32 v74, v42, v40, s[70:71]
    v_cndmask_b32 v75, v43, v41, s[70:71]
    v_xor_b32 v69, 8, v68
    v_xor_b32 v70, 16, v68
    v_xor_b32 v71, 24, v68
    v_perm_b32 v76, v73, v72, v4
    v_perm_b32 v77, v73, v72, v5
    v_perm_b32 v78, v73, v72, v6
    v_perm_b32 v79, v73, v72, v7
    v_mul_f32 v76, v66, v76
    v_mul_f32 v77, v66, v77
    v_mul_f32 v78, v66, v78
    v_mul_f32 v79, v66, v79
    v_cvt_f64_f32 v[80:81], v76
    v_cvt_f64_f32 v[82:83], v77
    v_cvt_f64_f32 v[84:85], v78
    v_cvt_f64_f32 v[86:87], v79
    ds_add_f64 v68, v[80:81] offset:6400
    ds_add_f64 v69, v[82:83] offset:6400
    ds_add_f64 v70, v[84:85] offset:6400
    ds_add_f64 v71, v[86:87] offset:6400
    v_perm_b32 v76, v75, v74, v4
    v_perm_b32 v77, v75, v74, v5
    v_perm_b32 v78, v75, v74, v6
    v_perm_b32 v79, v75, v74, v7
    v_xor_b32 v68, 32, v68
    v_xor_b32 v69, 32, v69
    v_xor_b32 v70, 32, v70
    v_xor_b32 v71, 32, v71
    v_mul_f32 v76, v66, v76
    v_mul_f32 v77, v66, v77
    v_mul_f32 v78, v66, v78
    v_mul_f32 v79, v66, v79
    v_cvt_f64_f32 v[80:81], v76
    v_cvt_f64_f32 v[82:83], v77
    v_cvt_f64_f32 v[84:85], v78
    v_cvt_f64_f32 v[86:87], v79
    ds_add_f64 v68, v[80:81] offset:6400
    ds_add_f64 v69, v[82:83] offset:6400
    ds_add_f64 v70, v[84:85] offset:6400
    ds_add_f64 v71, v[86:87] offset:6400
KB_LOOPED:
    s_waitcnt vmcnt(0)
    s_cmp_lg_u32 s86, 2
    s_cbranch_scc1 KB_NEXT_PASS
KB_DONE:
    v_and_b32 v64, 15, v1
    v_lshrrev_b32 v65, 4, v1
    v_bfe_u32 v66, v1, 2, 1
    v_bfe_u32 v67, v1, 1, 1
    v_lshlrev_b32 v64, 7, v64
    s_lshl_b32 s74, s3, 11
    v_lshl_add_u32 v64, v65, 5, v64
    v_lshlrev_b32 v66, 6, v66
    v_lshl_add_u32 v64, v67, 4, v64
    v_xor_b32 v64, v64, v66
    v_add_u32 v64, s74, v64
    s_mov_b32 s70, 0xcccccccc
    s_mov_b32 s71, 0xcccccccc
    v_add_u32 v65, 0x10000, v64
    v_xor_b32 v66, 16, v64
    v_xor_b32 v67, 16, v65
    v_lshlrev_b32 v32, 16, v98
    v_and_b32 v33, v96, v98
    v_lshlrev_b32 v34, 16, v99
    v_and_b32 v35, v96, v99
    v_lshlrev_b32 v44, 16, v120
    v_and_b32 v45, v96, v120
    v_lshlrev_b32 v46, 16, v121
    v_and_b32 v47, v96, v121
    v_lshlrev_b32 v36, 16, v100
    v_and_b32 v37, v96, v100
    v_lshlrev_b32 v38, 16, v101
    v_and_b32 v39, v96, v101
    v_lshlrev_b32 v48, 16, v122
    v_and_b32 v49, v96, v122
    v_lshlrev_b32 v50, 16, v123
    v_and_b32 v51, v96, v123
    v_lshlrev_b32 v40, 16, v102
    v_and_b32 v41, v96, v102
    v_lshlrev_b32 v42, 16, v103
    v_and_b32 v43, v96, v103
    v_lshlrev_b32 v52, 16, v124
    v_and_b32 v53, v96, v124
    v_lshlrev_b32 v54, 16, v125
    v_and_b32 v55, v96, v125
    s_waitcnt lgkmcnt(0)
    s_barrier
    s_cmp_ge_u32 s3, 8
    s_cbranch_scc1 KB_TWO_TILES
    ds_read_b128 v[8:11], v64 offset:6400
    ds_read_b128 v[12:15], v66 offset:6400
    ds_read_b128 v[16:19], v64 offset:39168
    ds_read_b128 v[20:23], v66 offset:39168
    ds_read_b128 v[24:27], v65 offset:6400
    ds_read_b128 v[28:31], v67 offset:6400
    s_waitcnt lgkmcnt(4)
    v_cvt_f32_f64 v68, v[8:9]
    v_cvt_f32_f64 v69, v[10:11]
    v_cvt_f32_f64 v70, v[12:13]
    v_cvt_f32_f64 v71, v[14:15]
    v_cvt_pk_bf16_f32 v68, v68, v69
    v_cvt_pk_bf16_f32 v70, v70, v71
    v_cndmask_b32 v80, v68, v70, s[70:71]
    v_cndmask_b32 v81, v70, v68, s[70:71]
    s_nop 1
    v_mfma_f32_16x16x16_bf16 v[8:11], v[104:105], v[80:81], 0
    s_waitcnt lgkmcnt(2)
    v_cvt_f32_f64 v72, v[16:17]
    v_cvt_f32_f64 v73, v[18:19]
    v_cvt_f32_f64 v74, v[20:21]
    v_cvt_f32_f64 v75, v[22:23]
    v_cvt_pk_bf16_f32 v72, v72, v73
    v_cvt_pk_bf16_f32 v74, v74, v75
    v_cndmask_b32 v82, v72, v74, s[70:71]
    v_cndmask_b32 v83, v74, v72, s[70:71]
    s_nop 1
    v_mfma_f32_16x16x16_bf16 v[16:19], v[104:105], v[82:83], 0
    s_waitcnt lgkmcnt(0)
    v_cvt_f32_f64 v76, v[24:25]
    v_cvt_f32_f64 v77, v[26:27]
    v_cvt_f32_f64 v78, v[28:29]
    v_cvt_f32_f64 v79, v[30:31]
    v_cvt_pk_bf16_f32 v76, v76, v77
    v_cvt_pk_bf16_f32 v78, v78, v79
    v_cndmask_b32 v84, v76, v78, s[70:71]
    v_cndmask_b32 v85, v78, v76, s[70:71]
    s_nop 1
    v_mfma_f32_16x16x16_bf16 v[24:27], v[104:105], v[84:85], 0
    v_mul_f32 v68, v8, v108
    v_mul_f32 v69, v9, v109
    v_mul_f32 v70, v10, v110
    v_mul_f32 v71, v11, v111
    v_cvt_pk_bf16_f32 v80, v68, v69
    v_cvt_pk_bf16_f32 v81, v70, v71
    s_nop 1
    v_mfma_f32_16x16x16_bf16 v[12:15], v[106:107], v[80:81], 0
    v_mul_f32 v72, v16, v112
    v_mul_f32 v73, v17, v113
    v_mul_f32 v74, v18, v114
    v_mul_f32 v75, v19, v115
    v_cvt_pk_bf16_f32 v82, v72, v73
    v_cvt_pk_bf16_f32 v83, v74, v75
    s_nop 1
    v_mfma_f32_16x16x16_bf16 v[20:23], v[106:107], v[82:83], 0
    v_mul_f32 v76, v24, v116
    v_mul_f32 v77, v25, v117
    v_mul_f32 v78, v26, v118
    v_mul_f32 v79, v27, v119
    v_cvt_pk_bf16_f32 v84, v76, v77
    v_cvt_pk_bf16_f32 v85, v78, v79
    s_nop 1
    v_mfma_f32_16x16x16_bf16 v[28:31], v[106:107], v[84:85], 0
    v_fmac_f32 v32, v12, v44
    v_fmac_f32 v33, v13, v45
    v_fmac_f32 v34, v14, v46
    v_fmac_f32 v35, v15, v47
    v_cvt_pk_bf16_f32 v80, v32, v33
    v_cvt_pk_bf16_f32 v81, v34, v35
    buffer_store_dwordx2 v[80:81], v97, s[60:63], 0 offen
    v_fmac_f32 v36, v20, v48
    v_fmac_f32 v37, v21, v49
    v_fmac_f32 v38, v22, v50
    v_fmac_f32 v39, v23, v51
    v_cvt_pk_bf16_f32 v82, v36, v37
    v_cvt_pk_bf16_f32 v83, v38, v39
    buffer_store_dwordx2 v[82:83], v126, s[60:63], 0 offen
    v_fmac_f32 v40, v28, v52
    v_fmac_f32 v41, v29, v53
    v_fmac_f32 v42, v30, v54
    v_fmac_f32 v43, v31, v55
    v_cvt_pk_bf16_f32 v84, v40, v41
    v_cvt_pk_bf16_f32 v85, v42, v43
    buffer_store_dwordx2 v[84:85], v127, s[60:63], 0 offen
    s_branch KB_STORED
KB_TWO_TILES:
    ds_read_b128 v[8:11], v64 offset:6400
    ds_read_b128 v[12:15], v66 offset:6400
    ds_read_b128 v[16:19], v64 offset:39168
    ds_read_b128 v[20:23], v66 offset:39168
    s_waitcnt lgkmcnt(2)
    v_cvt_f32_f64 v68, v[8:9]
    v_cvt_f32_f64 v69, v[10:11]
    v_cvt_f32_f64 v70, v[12:13]
    v_cvt_f32_f64 v71, v[14:15]
    v_cvt_pk_bf16_f32 v68, v68, v69
    v_cvt_pk_bf16_f32 v70, v70, v71
    v_cndmask_b32 v80, v68, v70, s[70:71]
    v_cndmask_b32 v81, v70, v68, s[70:71]
    s_nop 1
    v_mfma_f32_16x16x16_bf16 v[8:11], v[104:105], v[80:81], 0
    s_waitcnt lgkmcnt(0)
    v_cvt_f32_f64 v72, v[16:17]
    v_cvt_f32_f64 v73, v[18:19]
    v_cvt_f32_f64 v74, v[20:21]
    v_cvt_f32_f64 v75, v[22:23]
    v_cvt_pk_bf16_f32 v72, v72, v73
    v_cvt_pk_bf16_f32 v74, v74, v75
    v_cndmask_b32 v82, v72, v74, s[70:71]
    v_cndmask_b32 v83, v74, v72, s[70:71]
    s_nop 1
    v_mfma_f32_16x16x16_bf16 v[16:19], v[104:105], v[82:83], 0
    v_mul_f32 v68, v8, v108
    v_mul_f32 v69, v9, v109
    v_mul_f32 v70, v10, v110
    v_mul_f32 v71, v11, v111
    v_cvt_pk_bf16_f32 v80, v68, v69
    v_cvt_pk_bf16_f32 v81, v70, v71
    s_nop 1
    v_mfma_f32_16x16x16_bf16 v[12:15], v[106:107], v[80:81], 0
    v_mul_f32 v72, v16, v112
    v_mul_f32 v73, v17, v113
    v_mul_f32 v74, v18, v114
    v_mul_f32 v75, v19, v115
    v_cvt_pk_bf16_f32 v82, v72, v73
    v_cvt_pk_bf16_f32 v83, v74, v75
    s_nop 1
    v_mfma_f32_16x16x16_bf16 v[20:23], v[106:107], v[82:83], 0
    v_fmac_f32 v32, v12, v44
    v_fmac_f32 v33, v13, v45
    v_fmac_f32 v34, v14, v46
    v_fmac_f32 v35, v15, v47
    v_cvt_pk_bf16_f32 v80, v32, v33
    v_cvt_pk_bf16_f32 v81, v34, v35
    buffer_store_dwordx2 v[80:81], v97, s[60:63], 0 offen
    s_nop 0
    v_fmac_f32 v36, v20, v48
    v_fmac_f32 v37, v21, v49
    v_fmac_f32 v38, v22, v50
    v_fmac_f32 v39, v23, v51
    v_cvt_pk_bf16_f32 v82, v36, v37
    v_cvt_pk_bf16_f32 v83, v38, v39
    buffer_store_dwordx2 v[82:83], v126, s[60:63], 0 offen
KB_STORED:
K_END:
    s_endpgm
.section .rodata,"a"
.p2align 6
.amdhsa_kernel standalone__molecular_angular_gemnet__graph_kernel
  .amdhsa_next_free_vgpr 128
  .amdhsa_next_free_sgpr 96
  .amdhsa_accum_offset 128
  .amdhsa_group_segment_fixed_size 0
  .amdhsa_kernarg_size 112
  .amdhsa_user_sgpr_count 2
  .amdhsa_user_sgpr_kernarg_segment_ptr 1
  .amdhsa_system_sgpr_workgroup_id_x 1
  .amdhsa_float_denorm_mode_32 3
.end_amdhsa_kernel
```
